```python
import torch

def _softmax(x, axis=-1):
    return torch.softmax(x, dim=axis)
def _gelu(x):
    return torch.nn.functional.gelu(x, approximate="tanh")
def _silu(x):
    return torch.nn.functional.silu(x)
def _sigmoid(x):
    return torch.sigmoid(x)
def _layernorm(x, axis=-1, eps=1e-5):
    m = x.mean(dim=axis, keepdim=True)
    v = x.var(dim=axis, keepdim=True, unbiased=False)
    return (x - m) / torch.sqrt(v + eps)
def _scatter_add(tgt, idx, src, axis=0):
    return tgt.clone().index_add_(axis, idx, src)
def _segment_sum(src, seg, n):
    out = torch.zeros((n,) + src.shape[1:], dtype=src.dtype)
    return out.index_add_(0, seg, src)
def _pad(x, pw):
    flat = tuple(v for pair in reversed(pw) for v in pair)
    return torch.nn.functional.pad(x, flat)

kernel_name = 'gated_mix__sliding_block_cached__mixer_channel_mlp__decode'

def setup_inputs():

    _w = (lambda a: (lambda t: t.to(torch.bfloat16) if t.is_floating_point() else t)(torch.as_tensor(a)))
    def _A_setup():
        B, Sq, D = 1, 1, 576
        Hq, Hkv, Sk, Dh = 32, 16, 32768, 128
        assert Hq % Hkv == 0, (Hq, Hkv)
        return {
            "x": _w((lambda *s: torch.randn(*s, dtype=torch.bfloat16) * 0.05)(B, Sq, D)),
            "k_cache": _w((lambda *s: torch.randn(*s, dtype=torch.bfloat16) * 6.4)(B, Hkv, Sk, Dh)),
            "v_cache": _w((lambda *s: torch.randn(*s, dtype=torch.bfloat16) * 0.4)(B, Hkv, Sk, Dh)),
            "wq": _w((lambda *s: torch.randn(*s, dtype=torch.bfloat16) * 6.4)(D, Hq * Dh) * (D ** -0.5)),
            "wo": _w((lambda *s: torch.randn(*s, dtype=torch.bfloat16) * 0.4)(Hq * Dh, D) * ((Hq * Dh) ** -0.5)),
        }
    _A_in = _A_setup()

    def _B_setup():
        B, S, D, F = 1, 1, 576, 4608
        return {
            "x": _w((lambda *s: torch.randn(*s, dtype=torch.bfloat16) * 0.05)(B, S, D)),
            "w1": _w((lambda *s: torch.randn(*s, dtype=torch.bfloat16) * 1.6)(D, F) * (D ** -0.5)),
            "b1": _w((lambda *s: torch.randn(*s, dtype=torch.bfloat16) * 0.8)(F)),
            "w2": _w((lambda *s: torch.randn(*s, dtype=torch.bfloat16) * 0.05)(F, D) * (F ** -0.5)),
            "b2": _w((lambda *s: torch.randn(*s, dtype=torch.bfloat16) * 0.05)(D)),
        }
    _B_in = _B_setup()

    return {
        "A_x": _A_in["x"],
        "A_k_cache": _A_in["k_cache"],
        "A_v_cache": _A_in["v_cache"],
        "A_wq": _A_in["wq"],
        "A_wo": _A_in["wo"],
        "B_x": _B_in["x"],
        "B_w1": _B_in["w1"],
        "B_b1": _B_in["b1"],
        "B_w2": _B_in["w2"],
        "B_b2": _B_in["b2"],
        "gate_w": _w((lambda *s: torch.randn(*s, dtype=torch.bfloat16) * 0.05)(576) * 16.0),
    }

def reference(A_x, A_k_cache, A_v_cache, A_wq, A_wo, B_x, B_w1, B_b1, B_w2, B_b2, gate_w):
    def _A_ref(x, k_cache, v_cache, wq, wo):
        B, Sq, D = x.shape
        Hq, Dh = 32, 128
        Hkv, Sk = k_cache.shape[1], k_cache.shape[2]
        W = min(4096, max(256, Sk // 4))
        rep = Hq // Hkv
        q = (lambda x, *d: x.permute(*d))((x @ wq).reshape(B, Sq, Hq, Dh), 0, 2, 1, 3)
        k = (lambda x, n, axis: torch.repeat_interleave(x, n, dim=axis))(k_cache[:, :, Sk - W:, :], rep, axis=1)
        v = (lambda x, n, axis: torch.repeat_interleave(x, n, dim=axis))(v_cache[:, :, Sk - W:, :], rep, axis=1)
        scores = torch.einsum("bhqd,bhkd->bhqk", q, k) * (Dh ** -0.5)
        p = _softmax(scores, axis=-1)
        o = torch.einsum("bhqk,bhkd->bhqd", p, v)
        return (lambda x, *d: x.permute(*d))(o, 0, 2, 1, 3).reshape(B, Sq, Hq * Dh) @ wo

    def _B_ref(x, w1, b1, w2, b2):
        y = _layernorm(x, axis=-1)
        h = _gelu(torch.einsum("bsd,df->bsf", y, w1) + b1)
        return torch.einsum("bsf,fd->bsd", h, w2) + b2

    x = A_x
    g = _sigmoid((x * gate_w).sum(-1, keepdims=True))
    a = _A_ref(x, A_k_cache, A_v_cache, A_wq, A_wo)
    b = _B_ref(x, B_w1, B_b1, B_w2, B_b2)
    return g * a + (1 - g) * b
```

```asm
; @launch grid=(256,1,1) block=(320,1,1) lds=25600
.amdgcn_target "amdgcn-amd-amdhsa--gfx950"
.text
.globl gated_mix__sliding_block_cached__mixer_channel_mlp__decode_kernel
.p2align 8
.type gated_mix__sliding_block_cached__mixer_channel_mlp__decode_kernel,@function
gated_mix__sliding_block_cached__mixer_channel_mlp__decode_kernel:
  s_cmp_ge_u32 s2, 256
  s_cbranch_scc1 L_END
  s_load_dwordx2 s[4:5], s[0:1], 0
  s_load_dwordx2 s[16:17], s[0:1], 24
  s_load_dwordx2 s[24:25], s[0:1], 48
  s_load_dwordx2 s[48:49], s[0:1], 104
  v_lshrrev_b32 v1, 6, v0
  v_and_b32 v0, 63, v0
  s_and_b32 s52, s2, 7
  v_readfirstlane_b32 s3, v1
  s_lshr_b32 s53, s2, 3
  s_add_u32 s57, s53, 4
  s_cmp_lt_u32 s53, 12
  s_cselect_b32 s57, s53, s57
  s_sub_u32 s58, s53, 15
  s_cmp_ge_u32 s53, 27
  s_cselect_b32 s57, s58, s57
  s_cmp_eq_u32 s53, 31
  s_cselect_b32 s57, 31, s57
  s_and_b32 s56, s57, 3
  s_cmp_lg_u32 s3, 0
  s_cbranch_scc1 L_STREAM
  s_load_dwordx4 s[8:11], s[0:1], 8
  s_load_dwordx2 s[12:13], s[0:1], 64
  s_load_dwordx2 s[20:21], s[0:1], 32
  s_mov_b32 s6, 1152
  s_mov_b32 s7, 0x00020000
  v_lshlrev_b32 v1, 4, v0
  v_lshlrev_b32 v2, 1, v0
  s_mul_i32 s58, s56, 288
  s_mul_hi_u32 s59, s53, 0x55555556
  s_mul_i32 s60, s59, 3
  s_sub_u32 s60, s53, s60
  s_mul_i32 s61, s60, 384
  s_and_b32 s55, s53, 1
  s_lshl_b32 s62, s52, 1
  s_add_u32 s55, s55, s62
  s_lshl_b32 s55, s55, 23
  s_lshr_b32 s62, s53, 1
  s_lshl_b32 s62, s62, 16
  s_add_u32 s55, s55, s62
  s_add_u32 s55, s55, 7340032
  v_mov_b32 v40, s55
  s_lshl_b32 s62, s52, 3
  s_add_u32 s62, s62, s59
  s_min_u32 s62, s62, 63
  s_mul_i32 s55, s62, 82944
  v_mov_b32 v41, s55
  s_mul_i32 s55, s62, 73728
  v_mov_b32 v42, s55
  v_mov_b32 v43, 4096
  s_waitcnt lgkmcnt(0)
  buffer_load_ushort v28, v2, s[4:7], s58 offen
  buffer_load_ushort v29, v2, s[4:7], s58 offen offset:128
  buffer_load_ushort v30, v2, s[4:7], s58 offen offset:256
  buffer_load_dwordx4 v[4:7], v1, s[4:7], 0 offen
  buffer_load_dwordx4 v[8:11], v1, s[4:7], 0 offen offset:1024
  buffer_load_ushort v31, v2, s[4:7], s61 offen
  buffer_load_ushort v32, v2, s[4:7], s61 offen offset:128
  buffer_load_ushort v33, v2, s[4:7], s61 offen offset:256
  s_mov_b32 exec_lo, 1
  s_mov_b32 exec_hi, 0
  global_load_dword v105, v40, s[8:9] nt
  global_load_dword v106, v40, s[10:11] nt
  global_load_dword v107, v41, s[12:13] nt
  global_load_dword v108, v42, s[20:21] nt
  global_load_dword v109, v43, s[48:49]
  s_mov_b64 exec, -1
  s_branch L_COMM
.p2align 6
L_STREAM:
  s_sub_u32 s54, s3, 1
  s_lshr_b32 s55, s57, 2
  s_lshl_b32 s57, s52, 3
  s_add_u32 s55, s55, s57
  s_lshl_b32 s55, s55, 7
  s_mul_i32 s56, s56, 18
  s_mul_i32 s57, s54, 5
  s_cmp_eq_u32 s54, 3
  s_subb_u32 s57, s57, 0
  s_add_u32 s56, s56, s57
  s_lshl_b32 s56, s56, 16
  s_add_u32 s55, s55, s56
  v_lshrrev_b32 v10, 3, v0
  v_and_b32 v11, 7, v0
  v_lshlrev_b32 v11, 4, v11
  v_lshl_add_u32 v2, v10, 13, v11
  s_mov_b32 s18, 4718592
  s_mov_b32 s19, 0x00020000
  s_cmp_ge_u32 s54, 2
  s_cselect_b32 s58, 1073741824, 0
  v_or_b32 v3, s58, v2
  s_mul_hi_u32 s59, s53, 0x55555556
  s_waitcnt lgkmcnt(0)
  buffer_load_dwordx4 v[128:131], v2, s[16:19], s55 offen nt
  s_add_u32 s55, s55, 65536
  buffer_load_dwordx4 v[132:135], v2, s[16:19], s55 offen nt
  s_add_u32 s55, s55, 65536
  buffer_load_dwordx4 v[136:139], v2, s[16:19], s55 offen nt
  s_add_u32 s55, s55, 65536
  buffer_load_dwordx4 v[140:143], v2, s[16:19], s55 offen nt
  s_add_u32 s55, s55, 65536
  buffer_load_dwordx4 v[144:147], v3, s[16:19], s55 offen nt
  s_load_dwordx2 s[8:9], s[0:1], 8
  s_load_dwordx2 s[12:13], s[0:1], 16
  s_load_dwordx2 s[32:33], s[0:1], 64
  s_load_dwordx2 s[20:21], s[0:1], 32
  s_load_dword s40, s[48:49], 0
  s_mul_i32 s60, s59, 3
  s_sub_u32 s60, s53, s60
  s_mov_b32 s62, s59
  s_mul_i32 s61, s52, 9
  s_add_u32 s61, s61, s62
  s_lshl_b32 s61, s61, 7
  s_mul_i32 s62, s60, 24
  s_mul_i32 s63, s54, 6
  s_add_u32 s62, s62, s63
  s_mul_i32 s62, s62, 73728
  s_add_u32 s56, s61, s62
  v_mul_u32_u24 v4, 9216, v10
  v_add_u32 v4, v4, v11
  s_cmp_ge_u32 s53, 27
  s_cselect_b32 s58, 1073741824, 0
  v_or_b32 v4, s58, v4
  s_mov_b32 s26, 5308416
  s_mov_b32 s27, 0x00020000
  buffer_load_dwordx4 v[148:151], v4, s[24:27], s56 offen nt
  s_add_u32 s56, s56, 73728
  buffer_load_dwordx4 v[152:155], v4, s[24:27], s56 offen nt
  s_add_u32 s56, s56, 73728
  buffer_load_dwordx4 v[156:159], v4, s[24:27], s56 offen nt
  s_add_u32 s56, s56, 73728
  buffer_load_dwordx4 v[160:163], v4, s[24:27], s56 offen nt
  s_add_u32 s56, s56, 73728
  buffer_load_dwordx4 v[164:167], v4, s[24:27], s56 offen nt
  s_add_u32 s56, s56, 73728
  buffer_load_dwordx4 v[168:171], v4, s[24:27], s56 offen nt
  s_mov_b32 s10, 0x08000000
  s_mov_b32 s11, 0x00020000
  s_mov_b32 s14, 0x08000000
  s_mov_b32 s15, 0x00020000
  s_mov_b32 s34, 5308416
  s_mov_b32 s35, 0x00020000
  s_mov_b32 s22, 4718592
  s_mov_b32 s23, 0x00020000
  s_mov_b32 s50, 544768
  s_mov_b32 s51, 0x00020000
  s_and_b32 s55, s53, 1
  s_lshl_b32 s56, s52, 1
  s_add_u32 s61, s55, s56
  s_lshl_b32 s55, s61, 23
  s_lshr_b32 s56, s53, 1
  s_lshl_b32 s58, s56, 16
  s_add_u32 s55, s55, s58
  s_lshl_b32 s58, s56, 12
  s_add_u32 s55, s55, s58
  s_lshl_b32 s58, s54, 10
  s_add_u32 s55, s55, s58
  s_add_u32 s55, s55, 7340032
  v_lshrrev_b32 v12, 4, v0
  v_lshlrev_b32 v5, 6, v12
  v_bfe_u32 v13, v0, 2, 2
  v_lshl_add_u32 v5, v13, 8, v5
  v_and_b32 v13, 3, v0
  v_lshl_add_u32 v5, v13, 4, v5
  v_lshlrev_b32 v6, 4, v0
  s_lshl_b32 s61, s52, 3
  s_add_u32 s59, s59, s61
  s_mul_i32 s60, s60, 3
  s_add_u32 s60, s60, s54
  s_lshl_b32 s61, s60, 7
  s_mul_i32 s62, s59, 82944
  s_add_u32 s62, s62, s61
  s_mul_i32 s63, s59, 73728
  s_add_u32 s63, s63, s61
  s_cmp_lt_u32 s53, 24
  s_cselect_b32 s41, 1, 0
  s_cmp_lt_u32 s54, 3
  s_cselect_b32 s41, s41, 0
  s_cmp_eq_u32 s41, 0
  s_cselect_b32 s58, 1073741824, 0
  v_mul_u32_u24 v7, 1152, v10
  v_add_u32 v7, v7, v11
  v_or_b32 v7, s58, v7
  v_lshlrev_b32 v9, 6, v12
  v_lshl_add_u32 v9, v13, 4, v9
  v_bfe_u32 v14, v0, 3, 1
  v_lshl_add_u32 v9, v14, 8, v9
  v_add_u32 v9, 16384, v9
  v_and_b32 v13, 1, v0
  v_lshlrev_b32 v13, 4, v13
  v_lshl_add_u32 v8, v10, 5, v13
  v_bfe_u32 v14, v0, 1, 2
  v_lshlrev_b32 v15, 2, v14
  v_sub_u32 v8, v8, v15
  v_add_u32 v8, 12, v8
  v_mov_b32 v16, 0xffff
  v_lshlrev_b32 v16, v13, v16
  v_cmp_eq_u32 vcc, 0, v14
  s_nop 1
  v_cndmask_b32 v12, 0, v16, vcc
  v_cmp_eq_u32 vcc, 1, v14
  s_nop 1
  v_cndmask_b32 v13, 0, v16, vcc
  v_cmp_eq_u32 vcc, 3, v14
  s_nop 1
  v_cndmask_b32 v15, 0, v16, vcc
  v_cmp_eq_u32 vcc, 2, v14
  s_nop 1
  v_cndmask_b32 v14, 0, v16, vcc
  s_lshl_b32 s57, s57, 8
  v_add_u32 v18, s57, v8
  v_add_u32 v62, 1024, v18
  s_mul_i32 s58, s54, 1536
  s_add_u32 s58, s58, 4608
  v_add_u32 v19, s58, v8
  v_add_u32 v63, 1024, v19
  s_lshl_b32 s58, s54, 10
  v_add_u32 v17, s58, v6
  s_waitcnt lgkmcnt(0)
  s_mul_i32 s40, s40, 0x9E3779B1
  s_add_u32 s40, s40, 0x7F4A7C15
  s_and_b32 s40, s40, 0xFFFFFFFE
  s_or_b32 s40, s40, 0x100
  s_barrier
  ds_read2_b32 v[20:21], v18 offset0:0 offset1:1
  ds_read2_b32 v[22:23], v18 offset0:2 offset1:3
  ds_read2_b32 v[24:25], v18 offset0:64 offset1:65
  ds_read2_b32 v[26:27], v18 offset0:66 offset1:67
  ds_read2_b32 v[28:29], v18 offset0:128 offset1:129
  ds_read2_b32 v[30:31], v18 offset0:130 offset1:131
  ds_read2_b32 v[32:33], v18 offset0:192 offset1:193
  ds_read2_b32 v[34:35], v18 offset0:194 offset1:195
  ds_read2_b32 v[36:37], v62 offset0:0 offset1:1
  ds_read2_b32 v[38:39], v62 offset0:2 offset1:3
  s_waitcnt lgkmcnt(8)
  s_waitcnt vmcnt(10)
  v_mfma_f32_16x16x32_bf16 v[44:47], v[20:23], v[128:131], 0
  s_waitcnt lgkmcnt(6)
  s_waitcnt vmcnt(9)
  v_mfma_f32_16x16x32_bf16 v[44:47], v[24:27], v[132:135], v[44:47]
  s_xor_b32 s58, s55, 0
  buffer_load_dwordx4 v[64:67], v5, s[8:11], s58 offen nt
  s_waitcnt lgkmcnt(4)
  s_waitcnt vmcnt(9)
  v_mfma_f32_16x16x32_bf16 v[44:47], v[28:31], v[136:139], v[44:47]
  s_xor_b32 s58, s55, 4096
  buffer_load_dwordx4 v[68:71], v5, s[8:11], s58 offen nt
  s_waitcnt lgkmcnt(2)
  s_waitcnt vmcnt(9)
  v_mfma_f32_16x16x32_bf16 v[44:47], v[32:35], v[140:143], v[44:47]
  s_xor_b32 s58, s55, 8192
  buffer_load_dwordx4 v[72:75], v5, s[8:11], s58 offen nt
  s_waitcnt lgkmcnt(0)
  s_waitcnt vmcnt(9)
  v_mfma_f32_16x16x32_bf16 v[44:47], v[36:39], v[144:147], v[44:47]
  s_nop 7
  ds_write_b128 v17, v[44:47] offset:17408
  s_waitcnt lgkmcnt(0)
  s_barrier
  ds_read2_b32 v[20:21], v19 offset0:0 offset1:1
  ds_read2_b32 v[22:23], v19 offset0:2 offset1:3
  ds_read2_b32 v[24:25], v19 offset0:64 offset1:65
  ds_read2_b32 v[26:27], v19 offset0:66 offset1:67
  ds_read2_b32 v[28:29], v19 offset0:128 offset1:129
  ds_read2_b32 v[30:31], v19 offset0:130 offset1:131
  ds_read2_b32 v[32:33], v19 offset0:192 offset1:193
  ds_read2_b32 v[34:35], v19 offset0:194 offset1:195
  ds_read2_b32 v[36:37], v63 offset0:0 offset1:1
  ds_read2_b32 v[38:39], v63 offset0:2 offset1:3
  ds_read2_b32 v[40:41], v63 offset0:64 offset1:65
  ds_read2_b32 v[42:43], v63 offset0:66 offset1:67
  s_waitcnt lgkmcnt(10)
  s_waitcnt vmcnt(8)
  v_mfma_f32_16x16x32_bf16 v[48:51], v[20:23], v[148:151], 0
  s_xor_b32 s58, s55, 12288
  buffer_load_dwordx4 v[76:79], v5, s[8:11], s58 offen nt
  s_waitcnt lgkmcnt(8)
  s_waitcnt vmcnt(8)
  v_mfma_f32_16x16x32_bf16 v[48:51], v[24:27], v[152:155], v[48:51]
  s_xor_b32 s58, s55, 16384
  buffer_load_dwordx4 v[80:83], v5, s[8:11], s58 offen nt
  s_waitcnt lgkmcnt(6)
  s_waitcnt vmcnt(8)
  v_mfma_f32_16x16x32_bf16 v[48:51], v[28:31], v[156:159], v[48:51]
  s_xor_b32 s58, s55, 20480
  buffer_load_dwordx4 v[84:87], v5, s[8:11], s58 offen nt
  s_waitcnt lgkmcnt(4)
  s_waitcnt vmcnt(8)
  v_mfma_f32_16x16x32_bf16 v[48:51], v[32:35], v[160:163], v[48:51]
  s_xor_b32 s58, s55, 24576
  buffer_load_dwordx4 v[88:91], v5, s[8:11], s58 offen nt
  s_waitcnt lgkmcnt(2)
  s_waitcnt vmcnt(8)
  v_mfma_f32_16x16x32_bf16 v[48:51], v[36:39], v[164:167], v[48:51]
  s_xor_b32 s58, s55, 28672
  buffer_load_dwordx4 v[92:95], v5, s[8:11], s58 offen nt
  s_waitcnt lgkmcnt(0)
  s_waitcnt vmcnt(8)
  v_mfma_f32_16x16x32_bf16 v[48:51], v[40:43], v[168:171], v[48:51]
  s_nop 7
  ds_write_b128 v17, v[48:51] offset:21504
  s_waitcnt lgkmcnt(0)
  s_barrier
  s_xor_b32 s58, s55, 32768
  buffer_load_dwordx4 v[96:99], v5, s[8:11], s58 offen nt
  s_xor_b32 s58, s55, 36864
  buffer_load_dwordx4 v[100:103], v5, s[8:11], s58 offen nt
  s_waitcnt vmcnt(9)
  s_xor_b32 s58, s55, 40960
  buffer_load_dwordx4 v[104:107], v5, s[8:11], s58 offen nt
  s_waitcnt vmcnt(9)
  s_xor_b32 s58, s55, 45056
  buffer_load_dwordx4 v[108:111], v5, s[8:11], s58 offen nt
  s_waitcnt vmcnt(9)
  s_xor_b32 s58, s55, 49152
  buffer_load_dwordx4 v[112:115], v5, s[8:11], s58 offen nt
  s_waitcnt vmcnt(9)
  s_xor_b32 s58, s55, 53248
  buffer_load_dwordx4 v[116:119], v5, s[8:11], s58 offen nt
  s_waitcnt vmcnt(9)
  s_xor_b32 s58, s55, 57344
  buffer_load_dwordx4 v[120:123], v5, s[8:11], s58 offen nt
  s_waitcnt vmcnt(9)
  s_xor_b32 s58, s55, 61440
  buffer_load_dwordx4 v[124:127], v5, s[8:11], s58 offen nt
  s_waitcnt vmcnt(9)
  s_xor_b32 s58, s55, 0
  buffer_load_dwordx4 v[128:131], v6, s[12:15], s58 offen nt
  s_waitcnt vmcnt(9)
  s_xor_b32 s58, s55, 4096
  buffer_load_dwordx4 v[132:135], v6, s[12:15], s58 offen nt
  s_waitcnt vmcnt(9)
  s_xor_b32 s58, s55, 8192
  buffer_load_dwordx4 v[136:139], v6, s[12:15], s58 offen nt
  s_waitcnt vmcnt(9)
  s_xor_b32 s58, s55, 12288
  buffer_load_dwordx4 v[140:143], v6, s[12:15], s58 offen nt
  s_waitcnt vmcnt(9)
  s_xor_b32 s58, s55, 16384
  buffer_load_dwordx4 v[144:147], v6, s[12:15], s58 offen nt
  s_waitcnt vmcnt(9)
  s_xor_b32 s58, s55, 20480
  buffer_load_dwordx4 v[148:151], v6, s[12:15], s58 offen nt
  s_waitcnt vmcnt(9)
  s_xor_b32 s58, s55, 24576
  buffer_load_dwordx4 v[152:155], v6, s[12:15], s58 offen nt
  s_waitcnt vmcnt(9)
  s_xor_b32 s58, s55, 28672
  buffer_load_dwordx4 v[156:159], v6, s[12:15], s58 offen nt
  s_waitcnt vmcnt(9)
  s_xor_b32 s58, s55, 32768
  buffer_load_dwordx4 v[160:163], v6, s[12:15], s58 offen nt
  s_waitcnt vmcnt(9)
  s_xor_b32 s58, s55, 36864
  buffer_load_dwordx4 v[164:167], v6, s[12:15], s58 offen nt
  s_waitcnt vmcnt(9)
  s_xor_b32 s58, s55, 40960
  buffer_load_dwordx4 v[168:171], v6, s[12:15], s58 offen nt
  s_waitcnt vmcnt(9)
  s_xor_b32 s58, s55, 45056
  buffer_load_dwordx4 v[172:175], v6, s[12:15], s58 offen nt
  s_barrier
  ds_read_b128 v[192:195], v9
  s_mov_b32 s42, 0x3db504f3
  s_mov_b32 s43, 0x3fb8aa3b
  s_waitcnt lgkmcnt(0)
  v_mfma_f32_16x16x32_bf16 v[20:23], v[64:67], v[192:195], 0
  v_mfma_f32_16x16x32_bf16 v[24:27], v[68:71], v[192:195], 0
  v_mfma_f32_16x16x32_bf16 v[28:31], v[72:75], v[192:195], 0
  v_mfma_f32_16x16x32_bf16 v[32:35], v[76:79], v[192:195], 0
  s_nop 4
  v_mov_b32_dpp v44, v20 quad_perm:[0,0,0,0] row_mask:0xf bank_mask:0xf bound_ctrl:1
  v_add_f32_dpp v44, v21, v44 quad_perm:[1,1,1,1] row_mask:0xf bank_mask:0xf bound_ctrl:1
  v_add_f32_dpp v44, v22, v44 quad_perm:[2,2,2,2] row_mask:0xf bank_mask:0xf bound_ctrl:1
  v_add_f32_dpp v44, v23, v44 quad_perm:[3,3,3,3] row_mask:0xf bank_mask:0xf bound_ctrl:1
  v_mfma_f32_16x16x32_bf16 v[20:23], v[80:83], v[192:195], 0
  v_mov_b32_dpp v45, v24 quad_perm:[0,0,0,0] row_mask:0xf bank_mask:0xf bound_ctrl:1
  v_add_f32_dpp v45, v25, v45 quad_perm:[1,1,1,1] row_mask:0xf bank_mask:0xf bound_ctrl:1
  v_add_f32_dpp v45, v26, v45 quad_perm:[2,2,2,2] row_mask:0xf bank_mask:0xf bound_ctrl:1
  v_add_f32_dpp v45, v27, v45 quad_perm:[3,3,3,3] row_mask:0xf bank_mask:0xf bound_ctrl:1
  v_cvt_pk_bf16_f32 v60, v44, v45
  v_lshlrev_b32 v44, 16, v60
  v_and_b32 v45, 0xffff0000, v60
  v_mul_f32 v44, s42, v44
  v_mul_f32 v45, s42, v45
  v_cvt_pk_bf16_f32 v60, v44, v45
  v_lshlrev_b32 v44, 16, v60
  v_and_b32 v45, 0xffff0000, v60
  v_mfma_f32_16x16x32_bf16 v[24:27], v[84:87], v[192:195], 0
  v_mov_b32_dpp v46, v28 quad_perm:[0,0,0,0] row_mask:0xf bank_mask:0xf bound_ctrl:1
  v_add_f32_dpp v46, v29, v46 quad_perm:[1,1,1,1] row_mask:0xf bank_mask:0xf bound_ctrl:1
  v_add_f32_dpp v46, v30, v46 quad_perm:[2,2,2,2] row_mask:0xf bank_mask:0xf bound_ctrl:1
  v_add_f32_dpp v46, v31, v46 quad_perm:[3,3,3,3] row_mask:0xf bank_mask:0xf bound_ctrl:1
  v_mfma_f32_16x16x32_bf16 v[28:31], v[88:91], v[192:195], 0
  v_mov_b32_dpp v47, v32 quad_perm:[0,0,0,0] row_mask:0xf bank_mask:0xf bound_ctrl:1
  v_add_f32_dpp v47, v33, v47 quad_perm:[1,1,1,1] row_mask:0xf bank_mask:0xf bound_ctrl:1
  v_add_f32_dpp v47, v34, v47 quad_perm:[2,2,2,2] row_mask:0xf bank_mask:0xf bound_ctrl:1
  v_add_f32_dpp v47, v35, v47 quad_perm:[3,3,3,3] row_mask:0xf bank_mask:0xf bound_ctrl:1
  v_cvt_pk_bf16_f32 v60, v46, v47
  v_lshlrev_b32 v46, 16, v60
  v_and_b32 v47, 0xffff0000, v60
  v_mul_f32 v46, s42, v46
  v_mul_f32 v47, s42, v47
  v_cvt_pk_bf16_f32 v60, v46, v47
  v_lshlrev_b32 v46, 16, v60
  v_and_b32 v47, 0xffff0000, v60
  s_xor_b32 s58, s55, 49152
  buffer_load_dwordx4 v[176:179], v6, s[12:15], s58 offen nt
  v_mfma_f32_16x16x32_bf16 v[32:35], v[92:95], v[192:195], 0
  v_mov_b32_dpp v48, v20 quad_perm:[0,0,0,0] row_mask:0xf bank_mask:0xf bound_ctrl:1
  v_add_f32_dpp v48, v21, v48 quad_perm:[1,1,1,1] row_mask:0xf bank_mask:0xf bound_ctrl:1
  v_add_f32_dpp v48, v22, v48 quad_perm:[2,2,2,2] row_mask:0xf bank_mask:0xf bound_ctrl:1
  v_add_f32_dpp v48, v23, v48 quad_perm:[3,3,3,3] row_mask:0xf bank_mask:0xf bound_ctrl:1
  v_mfma_f32_16x16x32_bf16 v[20:23], v[96:99], v[192:195], 0
  v_mov_b32_dpp v49, v24 quad_perm:[0,0,0,0] row_mask:0xf bank_mask:0xf bound_ctrl:1
  v_add_f32_dpp v49, v25, v49 quad_perm:[1,1,1,1] row_mask:0xf bank_mask:0xf bound_ctrl:1
  v_add_f32_dpp v49, v26, v49 quad_perm:[2,2,2,2] row_mask:0xf bank_mask:0xf bound_ctrl:1
  v_add_f32_dpp v49, v27, v49 quad_perm:[3,3,3,3] row_mask:0xf bank_mask:0xf bound_ctrl:1
  v_cvt_pk_bf16_f32 v60, v48, v49
  v_lshlrev_b32 v48, 16, v60
  v_and_b32 v49, 0xffff0000, v60
  v_mul_f32 v48, s42, v48
  v_mul_f32 v49, s42, v49
  v_cvt_pk_bf16_f32 v60, v48, v49
  v_lshlrev_b32 v48, 16, v60
  v_and_b32 v49, 0xffff0000, v60
  v_mfma_f32_16x16x32_bf16 v[24:27], v[100:103], v[192:195], 0
  v_mov_b32_dpp v50, v28 quad_perm:[0,0,0,0] row_mask:0xf bank_mask:0xf bound_ctrl:1
  v_add_f32_dpp v50, v29, v50 quad_perm:[1,1,1,1] row_mask:0xf bank_mask:0xf bound_ctrl:1
  v_add_f32_dpp v50, v30, v50 quad_perm:[2,2,2,2] row_mask:0xf bank_mask:0xf bound_ctrl:1
  v_add_f32_dpp v50, v31, v50 quad_perm:[3,3,3,3] row_mask:0xf bank_mask:0xf bound_ctrl:1
  v_mfma_f32_16x16x32_bf16 v[28:31], v[104:107], v[192:195], 0
  v_mov_b32_dpp v51, v32 quad_perm:[0,0,0,0] row_mask:0xf bank_mask:0xf bound_ctrl:1
  v_add_f32_dpp v51, v33, v51 quad_perm:[1,1,1,1] row_mask:0xf bank_mask:0xf bound_ctrl:1
  v_add_f32_dpp v51, v34, v51 quad_perm:[2,2,2,2] row_mask:0xf bank_mask:0xf bound_ctrl:1
  v_add_f32_dpp v51, v35, v51 quad_perm:[3,3,3,3] row_mask:0xf bank_mask:0xf bound_ctrl:1
  v_cvt_pk_bf16_f32 v60, v50, v51
  v_lshlrev_b32 v50, 16, v60
  v_and_b32 v51, 0xffff0000, v60
  v_mul_f32 v50, s42, v50
  v_mul_f32 v51, s42, v51
  v_cvt_pk_bf16_f32 v60, v50, v51
  v_lshlrev_b32 v50, 16, v60
  v_and_b32 v51, 0xffff0000, v60
  s_xor_b32 s58, s55, 53248
  buffer_load_dwordx4 v[180:183], v6, s[12:15], s58 offen nt
  v_mfma_f32_16x16x32_bf16 v[32:35], v[108:111], v[192:195], 0
  v_mov_b32_dpp v52, v20 quad_perm:[0,0,0,0] row_mask:0xf bank_mask:0xf bound_ctrl:1
  v_add_f32_dpp v52, v21, v52 quad_perm:[1,1,1,1] row_mask:0xf bank_mask:0xf bound_ctrl:1
  v_add_f32_dpp v52, v22, v52 quad_perm:[2,2,2,2] row_mask:0xf bank_mask:0xf bound_ctrl:1
  v_add_f32_dpp v52, v23, v52 quad_perm:[3,3,3,3] row_mask:0xf bank_mask:0xf bound_ctrl:1
  v_mfma_f32_16x16x32_bf16 v[20:23], v[112:115], v[192:195], 0
  v_mov_b32_dpp v53, v24 quad_perm:[0,0,0,0] row_mask:0xf bank_mask:0xf bound_ctrl:1
  v_add_f32_dpp v53, v25, v53 quad_perm:[1,1,1,1] row_mask:0xf bank_mask:0xf bound_ctrl:1
  v_add_f32_dpp v53, v26, v53 quad_perm:[2,2,2,2] row_mask:0xf bank_mask:0xf bound_ctrl:1
  v_add_f32_dpp v53, v27, v53 quad_perm:[3,3,3,3] row_mask:0xf bank_mask:0xf bound_ctrl:1
  v_cvt_pk_bf16_f32 v60, v52, v53
  v_lshlrev_b32 v52, 16, v60
  v_and_b32 v53, 0xffff0000, v60
  v_mul_f32 v52, s42, v52
  v_mul_f32 v53, s42, v53
  v_cvt_pk_bf16_f32 v60, v52, v53
  v_lshlrev_b32 v52, 16, v60
  v_and_b32 v53, 0xffff0000, v60
  v_mfma_f32_16x16x32_bf16 v[24:27], v[116:119], v[192:195], 0
  v_mov_b32_dpp v54, v28 quad_perm:[0,0,0,0] row_mask:0xf bank_mask:0xf bound_ctrl:1
  v_add_f32_dpp v54, v29, v54 quad_perm:[1,1,1,1] row_mask:0xf bank_mask:0xf bound_ctrl:1
  v_add_f32_dpp v54, v30, v54 quad_perm:[2,2,2,2] row_mask:0xf bank_mask:0xf bound_ctrl:1
  v_add_f32_dpp v54, v31, v54 quad_perm:[3,3,3,3] row_mask:0xf bank_mask:0xf bound_ctrl:1
  v_mfma_f32_16x16x32_bf16 v[28:31], v[120:123], v[192:195], 0
  v_mov_b32_dpp v55, v32 quad_perm:[0,0,0,0] row_mask:0xf bank_mask:0xf bound_ctrl:1
  v_add_f32_dpp v55, v33, v55 quad_perm:[1,1,1,1] row_mask:0xf bank_mask:0xf bound_ctrl:1
  v_add_f32_dpp v55, v34, v55 quad_perm:[2,2,2,2] row_mask:0xf bank_mask:0xf bound_ctrl:1
  v_add_f32_dpp v55, v35, v55 quad_perm:[3,3,3,3] row_mask:0xf bank_mask:0xf bound_ctrl:1
  v_cvt_pk_bf16_f32 v60, v54, v55
  v_lshlrev_b32 v54, 16, v60
  v_and_b32 v55, 0xffff0000, v60
  v_mul_f32 v54, s42, v54
  v_mul_f32 v55, s42, v55
  v_cvt_pk_bf16_f32 v60, v54, v55
  v_lshlrev_b32 v54, 16, v60
  v_and_b32 v55, 0xffff0000, v60
  s_xor_b32 s58, s55, 57344
  buffer_load_dwordx4 v[184:187], v6, s[12:15], s58 offen nt
  v_mfma_f32_16x16x32_bf16 v[32:35], v[124:127], v[192:195], 0
  v_mov_b32_dpp v56, v20 quad_perm:[0,0,0,0] row_mask:0xf bank_mask:0xf bound_ctrl:1
  v_add_f32_dpp v56, v21, v56 quad_perm:[1,1,1,1] row_mask:0xf bank_mask:0xf bound_ctrl:1
  v_add_f32_dpp v56, v22, v56 quad_perm:[2,2,2,2] row_mask:0xf bank_mask:0xf bound_ctrl:1
  v_add_f32_dpp v56, v23, v56 quad_perm:[3,3,3,3] row_mask:0xf bank_mask:0xf bound_ctrl:1
  v_mov_b32_dpp v57, v24 quad_perm:[0,0,0,0] row_mask:0xf bank_mask:0xf bound_ctrl:1
  v_add_f32_dpp v57, v25, v57 quad_perm:[1,1,1,1] row_mask:0xf bank_mask:0xf bound_ctrl:1
  v_add_f32_dpp v57, v26, v57 quad_perm:[2,2,2,2] row_mask:0xf bank_mask:0xf bound_ctrl:1
  v_add_f32_dpp v57, v27, v57 quad_perm:[3,3,3,3] row_mask:0xf bank_mask:0xf bound_ctrl:1
  v_cvt_pk_bf16_f32 v60, v56, v57
  v_lshlrev_b32 v56, 16, v60
  v_and_b32 v57, 0xffff0000, v60
  v_mul_f32 v56, s42, v56
  v_mul_f32 v57, s42, v57
  v_cvt_pk_bf16_f32 v60, v56, v57
  v_lshlrev_b32 v56, 16, v60
  v_and_b32 v57, 0xffff0000, v60
  v_mov_b32_dpp v58, v28 quad_perm:[0,0,0,0] row_mask:0xf bank_mask:0xf bound_ctrl:1
  v_add_f32_dpp v58, v29, v58 quad_perm:[1,1,1,1] row_mask:0xf bank_mask:0xf bound_ctrl:1
  v_add_f32_dpp v58, v30, v58 quad_perm:[2,2,2,2] row_mask:0xf bank_mask:0xf bound_ctrl:1
  v_add_f32_dpp v58, v31, v58 quad_perm:[3,3,3,3] row_mask:0xf bank_mask:0xf bound_ctrl:1
  v_mov_b32_dpp v59, v32 quad_perm:[0,0,0,0] row_mask:0xf bank_mask:0xf bound_ctrl:1
  v_add_f32_dpp v59, v33, v59 quad_perm:[1,1,1,1] row_mask:0xf bank_mask:0xf bound_ctrl:1
  v_add_f32_dpp v59, v34, v59 quad_perm:[2,2,2,2] row_mask:0xf bank_mask:0xf bound_ctrl:1
  v_add_f32_dpp v59, v35, v59 quad_perm:[3,3,3,3] row_mask:0xf bank_mask:0xf bound_ctrl:1
  v_cvt_pk_bf16_f32 v60, v58, v59
  v_lshlrev_b32 v58, 16, v60
  v_and_b32 v59, 0xffff0000, v60
  v_mul_f32 v58, s42, v58
  v_mul_f32 v59, s42, v59
  v_cvt_pk_bf16_f32 v60, v58, v59
  v_lshlrev_b32 v58, 16, v60
  v_and_b32 v59, 0xffff0000, v60
  s_xor_b32 s58, s55, 61440
  buffer_load_dwordx4 v[188:191], v6, s[12:15], s58 offen nt
  v_max3_f32 v62, v44, v45, v46
  v_max3_f32 v62, v62, v47, v48
  v_max3_f32 v62, v62, v49, v50
  v_max3_f32 v62, v62, v51, v52
  v_max3_f32 v62, v62, v53, v54
  v_max3_f32 v62, v62, v55, v56
  v_max3_f32 v62, v62, v57, v58
  v_max_f32 v62, v62, v59
  v_mov_b32 v60, v62
  s_nop 1
  v_permlane16_swap_b32 v62, v60
  v_max_f32 v62, v62, v60
  v_mov_b32 v60, v62
  s_nop 1
  v_permlane32_swap_b32 v62, v60
  v_max_f32 v62, v62, v60
  v_mul_f32 v62, s43, v62
  v_fma_f32 v44, v44, s43, -v62
  v_fma_f32 v45, v45, s43, -v62
  v_fma_f32 v46, v46, s43, -v62
  v_fma_f32 v47, v47, s43, -v62
  v_fma_f32 v48, v48, s43, -v62
  v_fma_f32 v49, v49, s43, -v62
  v_fma_f32 v50, v50, s43, -v62
  v_fma_f32 v51, v51, s43, -v62
  v_fma_f32 v52, v52, s43, -v62
  v_fma_f32 v53, v53, s43, -v62
  v_fma_f32 v54, v54, s43, -v62
  v_fma_f32 v55, v55, s43, -v62
  v_fma_f32 v56, v56, s43, -v62
  v_fma_f32 v57, v57, s43, -v62
  v_fma_f32 v58, v58, s43, -v62
  v_fma_f32 v59, v59, s43, -v62
  v_exp_f32 v44, v44
  v_exp_f32 v45, v45
  v_exp_f32 v46, v46
  v_exp_f32 v47, v47
  v_exp_f32 v48, v48
  v_exp_f32 v49, v49
  v_exp_f32 v50, v50
  v_exp_f32 v51, v51
  v_exp_f32 v52, v52
  v_exp_f32 v53, v53
  v_exp_f32 v54, v54
  v_exp_f32 v55, v55
  v_exp_f32 v56, v56
  v_exp_f32 v57, v57
  v_exp_f32 v58, v58
  v_exp_f32 v59, v59
  v_add_f32 v63, v44, v45
  v_add_f32 v60, v46, v47
  v_add_f32 v63, v63, v48
  v_add_f32 v60, v60, v49
  v_add_f32 v63, v63, v50
  v_add_f32 v60, v60, v51
  v_add_f32 v63, v63, v52
  v_add_f32 v60, v60, v53
  v_add_f32 v63, v63, v54
  v_add_f32 v60, v60, v55
  v_add_f32 v63, v63, v56
  v_add_f32 v60, v60, v57
  v_add_f32 v63, v63, v58
  v_add_f32 v60, v60, v59
  v_add_f32 v63, v63, v60
  v_mov_b32 v60, v63
  s_nop 1
  v_permlane16_swap_b32 v63, v60
  v_add_f32 v63, v63, v60
  v_mov_b32 v60, v63
  s_nop 1
  v_permlane32_swap_b32 v63, v60
  v_add_f32 v63, v63, v60
  s_lshl_b32 s58, s54, 4
  s_add_u32 s58, s58, 15360
  v_and_b32 v60, 8, v0
  v_add_u32 v60, s58, v60
  s_mov_b32 exec_lo, 0x101
  s_mov_b32 exec_hi, 0
  ds_write_b64 v60, v[62:63]
  s_mov_b64 exec, -1
  v_cvt_pk_bf16_f32 v44, v44, v44
  v_cvt_pk_bf16_f32 v45, v45, v45
  v_cvt_pk_bf16_f32 v46, v46, v46
  v_cvt_pk_bf16_f32 v47, v47, v47
  v_cvt_pk_bf16_f32 v48, v48, v48
  v_cvt_pk_bf16_f32 v49, v49, v49
  v_cvt_pk_bf16_f32 v50, v50, v50
  v_cvt_pk_bf16_f32 v51, v51, v51
  v_cvt_pk_bf16_f32 v52, v52, v52
  v_cvt_pk_bf16_f32 v53, v53, v53
  v_cvt_pk_bf16_f32 v54, v54, v54
  v_cvt_pk_bf16_f32 v55, v55, v55
  v_cvt_pk_bf16_f32 v56, v56, v56
  v_cvt_pk_bf16_f32 v57, v57, v57
  v_cvt_pk_bf16_f32 v58, v58, v58
  v_cvt_pk_bf16_f32 v59, v59, v59
  v_and_b32 v20, v44, v12
  v_and_b32 v21, v44, v13
  v_and_b32 v22, v44, v14
  v_and_b32 v23, v44, v15
  v_and_b32 v24, v45, v12
  v_and_b32 v25, v45, v13
  v_and_b32 v26, v45, v14
  v_and_b32 v27, v45, v15
  v_and_b32 v28, v46, v12
  v_and_b32 v29, v46, v13
  v_and_b32 v30, v46, v14
  v_and_b32 v31, v46, v15
  v_mfma_f32_16x16x32_bf16 v[36:39], v[20:23], v[128:131], 0
  buffer_load_dwordx4 v[64:67], v7, s[32:35], s62 offen nt
  s_add_u32 s62, s62, 9216
  v_and_b32 v20, v47, v12
  v_and_b32 v21, v47, v13
  v_and_b32 v22, v47, v14
  v_and_b32 v23, v47, v15
  v_mfma_f32_16x16x32_bf16 v[36:39], v[24:27], v[132:135], v[36:39]
  buffer_load_dwordx4 v[68:71], v7, s[32:35], s62 offen nt
  s_add_u32 s62, s62, 9216
  v_and_b32 v24, v48, v12
  v_and_b32 v25, v48, v13
  v_and_b32 v26, v48, v14
  v_and_b32 v27, v48, v15
  s_waitcnt vmcnt(15)
  v_mfma_f32_16x16x32_bf16 v[36:39], v[28:31], v[136:139], v[36:39]
  buffer_load_dwordx4 v[72:75], v7, s[32:35], s62 offen nt
  s_add_u32 s62, s62, 9216
  v_and_b32 v28, v49, v12
  v_and_b32 v29, v49, v13
  v_and_b32 v30, v49, v14
  v_and_b32 v31, v49, v15
  s_waitcnt vmcnt(15)
  v_mfma_f32_16x16x32_bf16 v[36:39], v[20:23], v[140:143], v[36:39]
  buffer_load_dwordx4 v[76:79], v7, s[32:35], s62 offen nt
  s_add_u32 s62, s62, 9216
  v_and_b32 v20, v50, v12
  v_and_b32 v21, v50, v13
  v_and_b32 v22, v50, v14
  v_and_b32 v23, v50, v15
  s_waitcnt vmcnt(15)
  v_mfma_f32_16x16x32_bf16 v[36:39], v[24:27], v[144:147], v[36:39]
  v_and_b32 v24, v51, v12
  v_and_b32 v25, v51, v13
  v_and_b32 v26, v51, v14
  v_and_b32 v27, v51, v15
  s_waitcnt vmcnt(14)
  v_mfma_f32_16x16x32_bf16 v[36:39], v[28:31], v[148:151], v[36:39]
  v_and_b32 v28, v52, v12
  v_and_b32 v29, v52, v13
  v_and_b32 v30, v52, v14
  v_and_b32 v31, v52, v15
  s_waitcnt vmcnt(13)
  v_mfma_f32_16x16x32_bf16 v[36:39], v[20:23], v[152:155], v[36:39]
  v_and_b32 v20, v53, v12
  v_and_b32 v21, v53, v13
  v_and_b32 v22, v53, v14
  v_and_b32 v23, v53, v15
  s_waitcnt vmcnt(12)
  v_mfma_f32_16x16x32_bf16 v[36:39], v[24:27], v[156:159], v[36:39]
  v_and_b32 v24, v54, v12
  v_and_b32 v25, v54, v13
  v_and_b32 v26, v54, v14
  v_and_b32 v27, v54, v15
  s_waitcnt vmcnt(11)
  v_mfma_f32_16x16x32_bf16 v[36:39], v[28:31], v[160:163], v[36:39]
  v_and_b32 v28, v55, v12
  v_and_b32 v29, v55, v13
  v_and_b32 v30, v55, v14
  v_and_b32 v31, v55, v15
  s_waitcnt vmcnt(10)
  v_mfma_f32_16x16x32_bf16 v[36:39], v[20:23], v[164:167], v[36:39]
  v_and_b32 v20, v56, v12
  v_and_b32 v21, v56, v13
  v_and_b32 v22, v56, v14
  v_and_b32 v23, v56, v15
  s_waitcnt vmcnt(9)
  v_mfma_f32_16x16x32_bf16 v[36:39], v[24:27], v[168:171], v[36:39]
  v_and_b32 v24, v57, v12
  v_and_b32 v25, v57, v13
  v_and_b32 v26, v57, v14
  v_and_b32 v27, v57, v15
  s_waitcnt vmcnt(8)
  v_mfma_f32_16x16x32_bf16 v[36:39], v[28:31], v[172:175], v[36:39]
  v_and_b32 v28, v58, v12
  v_and_b32 v29, v58, v13
  v_and_b32 v30, v58, v14
  v_and_b32 v31, v58, v15
  s_waitcnt vmcnt(7)
  v_mfma_f32_16x16x32_bf16 v[36:39], v[20:23], v[176:179], v[36:39]
  v_and_b32 v20, v59, v12
  v_and_b32 v21, v59, v13
  v_and_b32 v22, v59, v14
  v_and_b32 v23, v59, v15
  s_waitcnt vmcnt(6)
  v_mfma_f32_16x16x32_bf16 v[36:39], v[24:27], v[180:183], v[36:39]
  s_waitcnt vmcnt(5)
  v_mfma_f32_16x16x32_bf16 v[36:39], v[28:31], v[184:187], v[36:39]
  s_waitcnt vmcnt(4)
  v_mfma_f32_16x16x32_bf16 v[36:39], v[20:23], v[188:191], v[36:39]
  s_nop 7
  ds_write_b128 v17, v[36:39] offset:17408
  s_waitcnt lgkmcnt(0)
  s_barrier
  s_cmp_eq_u32 s41, 0
  s_cbranch_scc1 L_S_EXIT
  buffer_load_dwordx4 v[80:83], v7, s[32:35], s62 offen nt
  s_add_u32 s62, s62, 9216
  buffer_load_dwordx4 v[84:87], v7, s[32:35], s62 offen nt
  s_add_u32 s62, s62, 9216
  buffer_load_dwordx4 v[88:91], v7, s[32:35], s62 offen nt
  s_add_u32 s62, s62, 9216
  buffer_load_dwordx4 v[92:95], v7, s[32:35], s62 offen nt
  s_add_u32 s62, s62, 9216
  buffer_load_dwordx4 v[96:99], v7, s[32:35], s62 offen nt
  v_add_u32 v60, 10752, v8
  v_add_u32 v61, 11776, v8
  v_add_u32 v62, 12800, v8
  v_mov_b32 v16, 16896
  ds_read_b64 v[18:19], v16
  ds_read2_b32 v[128:129], v60 offset0:0 offset1:1
  ds_read2_b32 v[130:131], v60 offset0:2 offset1:3
  ds_read2_b32 v[132:133], v60 offset0:64 offset1:65
  ds_read2_b32 v[134:135], v60 offset0:66 offset1:67
  ds_read2_b32 v[136:137], v60 offset0:128 offset1:129
  ds_read2_b32 v[138:139], v60 offset0:130 offset1:131
  ds_read2_b32 v[140:141], v60 offset0:192 offset1:193
  ds_read2_b32 v[142:143], v60 offset0:194 offset1:195
  ds_read2_b32 v[144:145], v61 offset0:0 offset1:1
  ds_read2_b32 v[146:147], v61 offset0:2 offset1:3
  s_waitcnt lgkmcnt(8)
  s_waitcnt vmcnt(8)
  v_mfma_f32_16x16x32_bf16 v[40:43], v[128:131], v[64:67], 0
  ds_read2_b32 v[148:149], v61 offset0:64 offset1:65
  ds_read2_b32 v[150:151], v61 offset0:66 offset1:67
  s_waitcnt lgkmcnt(8)
  s_waitcnt vmcnt(7)
  v_mfma_f32_16x16x32_bf16 v[40:43], v[132:135], v[68:71], v[40:43]
  ds_read2_b32 v[152:153], v61 offset0:128 offset1:129
  ds_read2_b32 v[154:155], v61 offset0:130 offset1:131
  s_waitcnt lgkmcnt(8)
  s_waitcnt vmcnt(6)
  v_mfma_f32_16x16x32_bf16 v[40:43], v[136:139], v[72:75], v[40:43]
  ds_read2_b32 v[156:157], v61 offset0:192 offset1:193
  ds_read2_b32 v[158:159], v61 offset0:194 offset1:195
  s_waitcnt lgkmcnt(8)
  s_waitcnt vmcnt(5)
  v_mfma_f32_16x16x32_bf16 v[40:43], v[140:143], v[76:79], v[40:43]
  ds_read2_b32 v[160:161], v62 offset0:0 offset1:1
  ds_read2_b32 v[162:163], v62 offset0:2 offset1:3
  s_waitcnt lgkmcnt(8)
  s_waitcnt vmcnt(4)
  v_mfma_f32_16x16x32_bf16 v[40:43], v[144:147], v[80:83], v[40:43]
  s_waitcnt lgkmcnt(6)
  s_waitcnt vmcnt(3)
  v_mfma_f32_16x16x32_bf16 v[40:43], v[148:151], v[84:87], v[40:43]
  s_waitcnt lgkmcnt(4)
  s_waitcnt vmcnt(2)
  v_mfma_f32_16x16x32_bf16 v[40:43], v[152:155], v[88:91], v[40:43]
  s_waitcnt lgkmcnt(2)
  s_waitcnt vmcnt(1)
  v_mfma_f32_16x16x32_bf16 v[40:43], v[156:159], v[92:95], v[40:43]
  s_waitcnt lgkmcnt(0)
  s_waitcnt vmcnt(0)
  v_mfma_f32_16x16x32_bf16 v[40:43], v[160:163], v[96:99], v[40:43]
  s_barrier
  buffer_load_dwordx4 v[100:103], v7, s[20:23], s63 offen nt
  s_add_u32 s63, s63, 9216
  buffer_load_dwordx4 v[104:107], v7, s[20:23], s63 offen nt
  s_add_u32 s63, s63, 9216
  buffer_load_dwordx4 v[108:111], v7, s[20:23], s63 offen nt
  s_add_u32 s63, s63, 9216
  buffer_load_dwordx4 v[112:115], v7, s[20:23], s63 offen nt
  s_add_u32 s63, s63, 9216
  buffer_load_dwordx4 v[116:119], v7, s[20:23], s63 offen nt
  s_add_u32 s63, s63, 9216
  buffer_load_dwordx4 v[120:123], v7, s[20:23], s63 offen nt
  s_add_u32 s63, s63, 9216
  buffer_load_dwordx4 v[124:127], v7, s[20:23], s63 offen nt
  s_add_u32 s63, s63, 9216
  buffer_load_dwordx4 v[196:199], v7, s[20:23], s63 offen nt
  v_mov_b32 v9, s40
  s_mov_b32 s44, 0x07060500
  s_mov_b32 s45, 0x07060501
  s_mov_b32 s46, 0x07060502
  s_mov_b32 s47, 0x07060503
  v_and_b32 v10, 7, v0
  v_lshrrev_b32 v11, 1, v10
  v_lshlrev_b32 v11, 12, v11
  v_and_b32 v10, 1, v10
  v_lshl_add_u32 v11, v10, 5, v11
  v_bfe_u32 v10, v0, 4, 1
  v_lshl_add_u32 v11, v10, 4, v11
  s_lshl_b32 s60, s60, 14
  s_lshl_b32 s59, s59, 6
  s_add_u32 s60, s60, s59
  s_add_u32 s60, s60, 397312
  v_add_u32 v60, 13056, v8
  v_add_u32 v61, 14080, v8
  v_mul_f32 v40, v19, v40
  v_mul_f32 v41, v19, v41
  v_mul_f32 v42, v19, v42
  v_mul_f32 v43, v19, v43
  s_barrier
  ds_read2_b32 v[164:165], v60 offset0:0 offset1:1
  ds_read2_b32 v[166:167], v60 offset0:2 offset1:3
  ds_read2_b32 v[168:169], v60 offset0:64 offset1:65
  ds_read2_b32 v[170:171], v60 offset0:66 offset1:67
  ds_read2_b32 v[172:173], v60 offset0:128 offset1:129
  ds_read2_b32 v[174:175], v60 offset0:130 offset1:131
  ds_read2_b32 v[176:177], v60 offset0:192 offset1:193
  ds_read2_b32 v[178:179], v60 offset0:194 offset1:195
  ds_read2_b32 v[180:181], v61 offset0:0 offset1:1
  ds_read2_b32 v[182:183], v61 offset0:2 offset1:3
  ds_read2_b32 v[184:185], v61 offset0:64 offset1:65
  ds_read2_b32 v[186:187], v61 offset0:66 offset1:67
  ds_read2_b32 v[188:189], v61 offset0:128 offset1:129
  ds_read2_b32 v[190:191], v61 offset0:130 offset1:131
  s_waitcnt lgkmcnt(12)
  s_waitcnt vmcnt(7)
  v_mfma_f32_16x16x32_bf16 v[44:47], v[164:167], v[100:103], 0
  ds_read2_b32 v[192:193], v61 offset0:192 offset1:193
  ds_read2_b32 v[194:195], v61 offset0:194 offset1:195
  s_waitcnt lgkmcnt(12)
  s_waitcnt vmcnt(6)
  v_mfma_f32_16x16x32_bf16 v[44:47], v[168:171], v[104:107], v[44:47]
  s_waitcnt lgkmcnt(10)
  s_waitcnt vmcnt(5)
  v_mfma_f32_16x16x32_bf16 v[44:47], v[172:175], v[108:111], v[44:47]
  s_waitcnt lgkmcnt(8)
  s_waitcnt vmcnt(4)
  v_mfma_f32_16x16x32_bf16 v[44:47], v[176:179], v[112:115], v[44:47]
  s_waitcnt lgkmcnt(6)
  s_waitcnt vmcnt(3)
  v_mfma_f32_16x16x32_bf16 v[44:47], v[180:183], v[116:119], v[44:47]
  s_waitcnt lgkmcnt(4)
  s_waitcnt vmcnt(2)
  v_mfma_f32_16x16x32_bf16 v[44:47], v[184:187], v[120:123], v[44:47]
  s_waitcnt lgkmcnt(2)
  s_waitcnt vmcnt(1)
  v_mfma_f32_16x16x32_bf16 v[44:47], v[188:191], v[124:127], v[44:47]
  s_waitcnt lgkmcnt(0)
  s_waitcnt vmcnt(0)
  v_mfma_f32_16x16x32_bf16 v[44:47], v[192:195], v[196:199], v[44:47]
  s_nop 7
  v_fma_f32 v44, v44, v18, v40
  v_fma_f32 v45, v45, v18, v41
  v_fma_f32 v46, v46, v18, v42
  v_fma_f32 v47, v47, v18, v43
  v_permlane32_swap_b32 v44, v45
  s_nop 0
  v_permlane32_swap_b32 v46, v47
  v_add_f32_dpp v48, v45, v44 row_ror:8 row_mask:0xf bank_mask:0xf bound_ctrl:1
  s_nop 0
  v_add_f32_dpp v50, v47, v46 row_ror:8 row_mask:0xf bank_mask:0xf bound_ctrl:1
  v_permlane32_swap_b32 v48, v49
  s_nop 0
  v_permlane32_swap_b32 v50, v51
  v_perm_b32 v48, v48, v9, s44
  v_perm_b32 v49, v49, v9, s45
  v_perm_b32 v50, v50, v9, s46
  v_perm_b32 v51, v51, v9, s47
  s_mov_b32 exec_lo, 0x00ff00ff
  s_mov_b32 exec_hi, 0
  buffer_store_dwordx4 v[48:51], v11, s[48:51], s60 offen sc1
L_S_EXIT:
  s_endpgm
.p2align 6
L_COMM:
  s_load_dwordx2 s[40:41], s[0:1], 80
  s_load_dwordx2 s[28:29], s[0:1], 56
  s_load_dwordx2 s[36:37], s[0:1], 72
  s_load_dwordx2 s[44:45], s[0:1], 88
  s_load_dword s33, s[48:49], 0
  v_mov_b32 v12, 0
  v_mov_b32 v13, 0
  v_mov_b32 v14, 0
  v_mov_b32 v15, 0
  ds_write_b128 v1, v[12:15] offset:0
  ds_write_b128 v1, v[12:15] offset:1024
  ds_write_b128 v1, v[12:15] offset:2048
  ds_write_b128 v1, v[12:15] offset:3072
  ds_write_b128 v1, v[12:15] offset:4096
  ds_write_b128 v1, v[12:15] offset:5120
  ds_write_b128 v1, v[12:15] offset:6144
  ds_write_b128 v1, v[12:15] offset:7168
  ds_write_b128 v1, v[12:15] offset:8192
  ds_write_b128 v1, v[12:15] offset:9216
  ds_write_b128 v1, v[12:15] offset:10240
  ds_write_b128 v1, v[12:15] offset:11264
  ds_write_b128 v1, v[12:15] offset:12288
  ds_write_b128 v1, v[12:15] offset:13312
  ds_write_b128 v1, v[12:15] offset:14336
  ds_write_b128 v1, v[12:15] offset:15360
  s_mov_b32 s42, 1152
  s_mov_b32 s43, 0x00020000
  s_mov_b32 s30, 9216
  s_mov_b32 s31, 0x00020000
  s_mov_b32 s38, 1152
  s_mov_b32 s39, 0x00020000
  s_mov_b32 s46, 1152
  s_mov_b32 s47, 0x00020000
  s_mov_b32 s50, 544768
  s_mov_b32 s51, 0x00020000
  v_lshlrev_b32 v25, 5, v0
  v_add_u32 v26, 2048, v25
  v_add_u32 v27, 4096, v25
  s_waitcnt lgkmcnt(0)
  buffer_load_dwordx4 v[12:15], v1, s[40:43], 0 offen
  buffer_load_dwordx4 v[16:19], v1, s[40:43], 0 offen offset:1024
  s_mov_b32 s62, s59
  s_lshl_b32 s61, s52, 3
  s_add_u32 s59, s59, s61
  s_mul_i32 s61, s59, 144
  v_lshlrev_b32 v2, 3, v0
  v_cmp_gt_u32 vcc, 18, v0
  v_mov_b32 v3, 1073741824
  s_nop 0
  v_cndmask_b32 v2, v3, v2, vcc
  s_cmp_lt_u32 s53, 24
  s_cselect_b32 s34, 1, 0
  s_cselect_b32 s58, 0, 1073741824
  v_or_b32 v2, s58, v2
  buffer_load_dwordx2 v[20:21], v2, s[28:31], s61 offen
  s_waitcnt vmcnt(13)
  v_lshlrev_b32 v34, 16, v28
  v_lshlrev_b32 v35, 16, v29
  v_lshlrev_b32 v36, 16, v30
  ds_write2_b32 v25, v28, v34 offset0:3 offset1:7
  ds_write2_b32 v26, v29, v35 offset0:3 offset1:7
  ds_write2_b32 v27, v30, v36 offset0:3 offset1:7
  s_waitcnt lgkmcnt(0)
  s_barrier
  s_waitcnt vmcnt(11)
  v_lshlrev_b32 v112, 16, v4
  v_and_b32 v113, 0xffff0000, v4
  v_lshlrev_b32 v114, 16, v5
  v_and_b32 v115, 0xffff0000, v5
  v_lshlrev_b32 v116, 16, v6
  v_and_b32 v117, 0xffff0000, v6
  v_lshlrev_b32 v118, 16, v7
  v_and_b32 v119, 0xffff0000, v7
  v_lshlrev_b32 v120, 16, v8
  v_and_b32 v121, 0xffff0000, v8
  v_lshlrev_b32 v122, 16, v9
  v_and_b32 v123, 0xffff0000, v9
  v_lshlrev_b32 v124, 16, v10
  v_and_b32 v125, 0xffff0000, v10
  v_lshlrev_b32 v126, 16, v11
  v_and_b32 v127, 0xffff0000, v11
  v_add_f32 v40, v112, v113
  v_add_f32 v41, v114, v115
  v_add_f32 v40, v40, v116
  v_add_f32 v41, v41, v117
  v_add_f32 v40, v40, v118
  v_add_f32 v41, v41, v119
  v_add_f32 v40, v40, v120
  v_add_f32 v41, v41, v121
  v_add_f32 v40, v40, v122
  v_add_f32 v41, v41, v123
  v_add_f32 v40, v40, v124
  v_add_f32 v41, v41, v125
  v_add_f32 v40, v40, v126
  v_add_f32 v41, v41, v127
  v_add_f32 v40, v40, v41
  s_nop 1
  v_add_f32_dpp v40, v40, v40 row_ror:8 row_mask:0xf bank_mask:0xf bound_ctrl:1
  s_nop 1
  v_add_f32_dpp v40, v40, v40 row_ror:4 row_mask:0xf bank_mask:0xf bound_ctrl:1
  s_nop 1
  v_add_f32_dpp v40, v40, v40 row_ror:2 row_mask:0xf bank_mask:0xf bound_ctrl:1
  s_nop 1
  v_add_f32_dpp v40, v40, v40 row_ror:1 row_mask:0xf bank_mask:0xf bound_ctrl:1
  v_mov_b32 v41, v40
  s_nop 1
  v_permlane16_swap_b32 v40, v41
  v_add_f32 v40, v40, v41
  v_mov_b32 v41, v40
  s_nop 1
  v_permlane32_swap_b32 v40, v41
  v_add_f32 v40, v40, v41
  v_mul_f32 v40, 0x3ae38e39, v40
  v_sub_f32 v80, v112, v40
  v_sub_f32 v81, v113, v40
  v_sub_f32 v82, v114, v40
  v_sub_f32 v83, v115, v40
  v_sub_f32 v84, v116, v40
  v_sub_f32 v85, v117, v40
  v_sub_f32 v86, v118, v40
  v_sub_f32 v87, v119, v40
  v_mul_f32 v42, v80, v80
  v_mul_f32 v43, v81, v81
  v_fmac_f32 v42, v82, v82
  v_fmac_f32 v43, v83, v83
  v_fmac_f32 v42, v84, v84
  v_fmac_f32 v43, v85, v85
  v_fmac_f32 v42, v86, v86
  v_fmac_f32 v43, v87, v87
  s_mov_b32 exec_lo, 0xff
  s_mov_b32 exec_hi, 0
  v_sub_f32 v80, v120, v40
  v_sub_f32 v81, v121, v40
  v_sub_f32 v82, v122, v40
  v_sub_f32 v83, v123, v40
  v_sub_f32 v84, v124, v40
  v_sub_f32 v85, v125, v40
  v_sub_f32 v86, v126, v40
  v_sub_f32 v87, v127, v40
  v_fmac_f32 v42, v80, v80
  v_fmac_f32 v43, v81, v81
  v_fmac_f32 v42, v82, v82
  v_fmac_f32 v43, v83, v83
  v_fmac_f32 v42, v84, v84
  v_fmac_f32 v43, v85, v85
  v_fmac_f32 v42, v86, v86
  v_fmac_f32 v43, v87, v87
  s_mov_b64 exec, -1
  v_add_f32 v42, v42, v43
  s_nop 1
  v_add_f32_dpp v42, v42, v42 row_ror:8 row_mask:0xf bank_mask:0xf bound_ctrl:1
  s_nop 1
  v_add_f32_dpp v42, v42, v42 row_ror:4 row_mask:0xf bank_mask:0xf bound_ctrl:1
  s_nop 1
  v_add_f32_dpp v42, v42, v42 row_ror:2 row_mask:0xf bank_mask:0xf bound_ctrl:1
  s_nop 1
  v_add_f32_dpp v42, v42, v42 row_ror:1 row_mask:0xf bank_mask:0xf bound_ctrl:1
  v_mov_b32 v43, v42
  s_nop 1
  v_permlane16_swap_b32 v42, v43
  v_add_f32 v42, v42, v43
  v_mov_b32 v43, v42
  s_nop 1
  v_permlane32_swap_b32 v42, v43
  v_add_f32 v42, v42, v43
  v_mul_f32 v42, 0x3ae38e39, v42
  v_cvt_pk_bf16_f32 v40, v40, v42
  v_and_b32 v42, 0xffff0000, v40
  v_lshlrev_b32 v40, 16, v40
  v_add_f32 v42, 0x3727c5ac, v42
  v_cvt_pk_bf16_f32 v42, v42, v42
  v_and_b32 v42, 0xffff0000, v42
  v_sqrt_f32 v42, v42
  s_nop 0
  v_cvt_pk_bf16_f32 v42, v42, v42
  v_and_b32 v42, 0xffff0000, v42
  v_rcp_f32 v42, v42
  s_waitcnt vmcnt(8)
  v_lshlrev_b32 v31, 16, v31
  v_sub_f32 v31, v31, v40
  v_lshlrev_b32 v32, 16, v32
  v_sub_f32 v32, v32, v40
  v_lshlrev_b32 v33, 16, v33
  v_sub_f32 v33, v33, v40
  v_cvt_pk_bf16_f32 v31, v31, v31
  v_and_b32 v31, 0xffff0000, v31
  v_mul_f32 v31, v31, v42
  v_cvt_pk_bf16_f32 v31, v31, v31
  v_and_b32 v34, 0xffff0000, v31
  v_and_b32 v31, 0xffff, v31
  v_cvt_pk_bf16_f32 v32, v32, v32
  v_and_b32 v32, 0xffff0000, v32
  v_mul_f32 v32, v32, v42
  v_cvt_pk_bf16_f32 v32, v32, v32
  v_and_b32 v35, 0xffff0000, v32
  v_and_b32 v32, 0xffff, v32
  v_cvt_pk_bf16_f32 v33, v33, v33
  v_and_b32 v33, 0xffff0000, v33
  v_mul_f32 v33, v33, v42
  v_cvt_pk_bf16_f32 v33, v33, v33
  v_and_b32 v36, 0xffff0000, v33
  v_and_b32 v33, 0xffff, v33
  v_add_u32 v25, 4608, v25
  v_add_u32 v26, 4608, v26
  v_add_u32 v27, 4608, v27
  ds_write2_b32 v25, v31, v34 offset0:3 offset1:7
  ds_write2_b32 v26, v32, v35 offset0:3 offset1:7
  ds_write2_b32 v27, v33, v36 offset0:3 offset1:7
  s_mul_i32 s32, s33, 0x9E3779B1
  s_add_u32 s32, s32, 0x7F4A7C15
  s_and_b32 s32, s32, 0xFFFFFFFE
  s_or_b32 s32, s32, 0x100
  v_mov_b32 v47, s32
  s_mov_b32 s8, 0x07060500
  s_mov_b32 s9, 0x07060501
  s_mov_b32 s10, 0x07060502
  s_mov_b32 s11, 0x07060503
  s_and_b32 s16, s32, 0xff
  s_bfe_u32 s17, s32, 0x80008
  s_bfe_u32 s18, s32, 0x80010
  s_lshr_b32 s19, s32, 24
  v_lshrrev_b32 v2, 5, v0
  v_mul_u32_u24 v2, 640, v2
  v_bfe_u32 v3, v0, 3, 1
  v_lshl_add_u32 v2, v3, 8, v2
  v_and_b32 v22, 7, v0
  v_lshl_add_u32 v2, v22, 4, v2
  s_lshr_b32 s55, s57, 2
  s_lshl_b32 s58, s52, 3
  s_add_u32 s55, s55, s58
  s_lshl_b32 s55, s55, 8
  s_lshl_b32 s56, s56, 14
  s_add_u32 s55, s55, s56
  s_add_u32 s55, s55, 4096
  s_mul_i32 s56, s52, 9
  s_add_u32 s56, s56, s62
  s_lshl_b32 s56, s56, 8
  s_mul_i32 s57, s60, 18432
  s_add_u32 s56, s56, s57
  s_add_u32 s56, s56, 69632
  s_cmp_ge_u32 s53, 27
  s_cselect_b32 s58, 1073741824, 0
  v_lshlrev_b32 v24, 5, v22
  v_lshl_add_u32 v24, v3, 4, v24
  v_or_b32 v25, s58, v24
  s_waitcnt lgkmcnt(0)
  s_barrier
  ds_read_b128 v[64:67], v2 offset:17408
  ds_read_b128 v[68:71], v2 offset:18432
  ds_read_b128 v[72:75], v2 offset:19456
  ds_read_b128 v[76:79], v2 offset:20480
  s_waitcnt lgkmcnt(2)
  v_add_f32 v64, v64, v68
  v_add_f32 v65, v65, v69
  v_add_f32 v66, v66, v70
  v_add_f32 v67, v67, v71
  s_waitcnt lgkmcnt(0)
  v_add_f32 v72, v72, v76
  v_add_f32 v73, v73, v77
  v_add_f32 v74, v74, v78
  v_add_f32 v75, v75, v79
  v_add_f32 v64, v64, v72
  v_add_f32 v65, v65, v73
  v_add_f32 v66, v66, v74
  v_add_f32 v67, v67, v75
  v_permlane32_swap_b32 v64, v65
  s_nop 0
  v_permlane32_swap_b32 v66, v67
  v_add_f32 v68, v64, v65
  v_add_f32 v70, v66, v67
  s_nop 0
  v_permlane32_swap_b32 v68, v69
  v_permlane32_swap_b32 v70, v71
  v_perm_b32 v68, v68, v47, s8
  v_perm_b32 v69, v69, v47, s9
  v_perm_b32 v70, v70, v47, s10
  v_perm_b32 v71, v71, v47, s11
  s_mov_b32 exec_lo, 0xffff
  s_mov_b32 exec_hi, 0
  buffer_store_dwordx4 v[68:71], v24, s[48:51], s55 offen sc1
  s_mov_b64 exec, -1
  s_barrier
  ds_read_b128 v[64:67], v2 offset:21504
  ds_read_b128 v[68:71], v2 offset:22528
  ds_read_b128 v[72:75], v2 offset:23552
  ds_read_b128 v[76:79], v2 offset:24576
  s_waitcnt lgkmcnt(2)
  v_add_f32 v64, v64, v68
  v_add_f32 v65, v65, v69
  v_add_f32 v66, v66, v70
  v_add_f32 v67, v67, v71
  s_waitcnt lgkmcnt(0)
  v_add_f32 v72, v72, v76
  v_add_f32 v73, v73, v77
  v_add_f32 v74, v74, v78
  v_add_f32 v75, v75, v79
  v_add_f32 v64, v64, v72
  v_add_f32 v65, v65, v73
  v_add_f32 v66, v66, v74
  v_add_f32 v67, v67, v75
  v_permlane32_swap_b32 v64, v65
  s_nop 0
  v_permlane32_swap_b32 v66, v67
  v_add_f32 v68, v64, v65
  v_add_f32 v70, v66, v67
  s_nop 0
  v_permlane32_swap_b32 v68, v69
  v_permlane32_swap_b32 v70, v71
  v_perm_b32 v68, v68, v47, s8
  v_perm_b32 v69, v69, v47, s9
  v_perm_b32 v70, v70, v47, s10
  v_perm_b32 v71, v71, v47, s11
  s_mov_b32 exec_lo, 0xffff
  s_mov_b32 exec_hi, 0
  buffer_store_dwordx4 v[68:71], v25, s[48:51], s56 offen sc1
  s_mov_b64 exec, -1
  s_waitcnt vmcnt(2)
  v_lshlrev_b32 v80, 16, v12
  v_and_b32 v81, 0xffff0000, v12
  v_mul_f32 v80, v80, v112
  v_mul_f32 v81, v81, v113
  v_cvt_pk_bf16_f32 v80, v80, v81
  v_lshlrev_b32 v81, 16, v80
  v_and_b32 v80, 0xffff0000, v80
  v_add_f32 v44, v80, v81
  v_lshlrev_b32 v80, 16, v13
  v_and_b32 v81, 0xffff0000, v13
  v_mul_f32 v80, v80, v114
  v_mul_f32 v81, v81, v115
  v_cvt_pk_bf16_f32 v80, v80, v81
  v_lshlrev_b32 v81, 16, v80
  v_and_b32 v80, 0xffff0000, v80
  v_add_f32 v44, v44, v80
  v_add_f32 v44, v44, v81
  v_lshlrev_b32 v80, 16, v14
  v_and_b32 v81, 0xffff0000, v14
  v_mul_f32 v80, v80, v116
  v_mul_f32 v81, v81, v117
  v_cvt_pk_bf16_f32 v80, v80, v81
  v_lshlrev_b32 v81, 16, v80
  v_and_b32 v80, 0xffff0000, v80
  v_add_f32 v44, v44, v80
  v_add_f32 v44, v44, v81
  v_lshlrev_b32 v80, 16, v15
  v_and_b32 v81, 0xffff0000, v15
  v_mul_f32 v80, v80, v118
  v_mul_f32 v81, v81, v119
  v_cvt_pk_bf16_f32 v80, v80, v81
  v_lshlrev_b32 v81, 16, v80
  v_and_b32 v80, 0xffff0000, v80
  v_add_f32 v44, v44, v80
  v_add_f32 v44, v44, v81
  v_lshlrev_b32 v80, 16, v16
  v_and_b32 v81, 0xffff0000, v16
  v_mul_f32 v80, v80, v120
  v_mul_f32 v81, v81, v121
  v_cvt_pk_bf16_f32 v80, v80, v81
  v_lshlrev_b32 v81, 16, v80
  v_and_b32 v80, 0xffff0000, v80
  v_add_f32 v44, v44, v80
  v_add_f32 v44, v44, v81
  v_lshlrev_b32 v80, 16, v17
  v_and_b32 v81, 0xffff0000, v17
  v_mul_f32 v80, v80, v122
  v_mul_f32 v81, v81, v123
  v_cvt_pk_bf16_f32 v80, v80, v81
  v_lshlrev_b32 v81, 16, v80
  v_and_b32 v80, 0xffff0000, v80
  v_add_f32 v44, v44, v80
  v_add_f32 v44, v44, v81
  v_lshlrev_b32 v80, 16, v18
  v_and_b32 v81, 0xffff0000, v18
  v_mul_f32 v80, v80, v124
  v_mul_f32 v81, v81, v125
  v_cvt_pk_bf16_f32 v80, v80, v81
  v_lshlrev_b32 v81, 16, v80
  v_and_b32 v80, 0xffff0000, v80
  v_add_f32 v44, v44, v80
  v_add_f32 v44, v44, v81
  v_lshlrev_b32 v80, 16, v19
  v_and_b32 v81, 0xffff0000, v19
  v_mul_f32 v80, v80, v126
  v_mul_f32 v81, v81, v127
  v_cvt_pk_bf16_f32 v80, v80, v81
  v_lshlrev_b32 v81, 16, v80
  v_and_b32 v80, 0xffff0000, v80
  v_add_f32 v44, v44, v80
  v_add_f32 v44, v44, v81
  s_nop 1
  v_add_f32_dpp v44, v44, v44 row_ror:8 row_mask:0xf bank_mask:0xf bound_ctrl:1
  s_nop 1
  v_add_f32_dpp v44, v44, v44 row_ror:4 row_mask:0xf bank_mask:0xf bound_ctrl:1
  s_nop 1
  v_add_f32_dpp v44, v44, v44 row_ror:2 row_mask:0xf bank_mask:0xf bound_ctrl:1
  s_nop 1
  v_add_f32_dpp v44, v44, v44 row_ror:1 row_mask:0xf bank_mask:0xf bound_ctrl:1
  v_mov_b32 v45, v44
  s_nop 1
  v_permlane16_swap_b32 v44, v45
  v_add_f32 v44, v44, v45
  v_mov_b32 v45, v44
  s_nop 1
  v_permlane32_swap_b32 v44, v45
  v_add_f32 v44, v44, v45
  v_cvt_pk_bf16_f32 v44, v44, v44
  v_and_b32 v44, 0xffff0000, v44
  v_mul_f32 v44, 0xbfb8aa3b, v44
  v_exp_f32 v44, v44
  s_nop 0
  v_add_f32 v44, 1.0, v44
  v_rcp_f32 v44, v44
  s_nop 0
  v_cvt_pk_bf16_f32 v44, v44, v44
  v_and_b32 v44, 0xffff0000, v44
  v_sub_f32 v45, 1.0, v44
  v_cvt_pk_bf16_f32 v45, v45, v45
  v_and_b32 v45, 0xffff0000, v45
  v_mov_b32 v46, 16896
  ds_write_b64 v46, v[44:45]
  s_and_b32 s55, s53, 1
  s_lshl_b32 s56, s52, 1
  s_add_u32 s55, s55, s56
  s_lshl_b32 s56, s55, 10
  s_add_u32 s56, s56, 4096
  s_mul_i32 s57, s59, 288
  s_add_u32 s57, s57, 69632
  v_lshlrev_b32 v3, 4, v0
  v_cmp_gt_u32 vcc, 18, v0
  v_mov_b32 v22, 1073741824
  s_nop 0
  v_cndmask_b32 v3, v22, v3, vcc
  s_cmp_eq_u32 s34, 0
  s_cselect_b32 s58, 1073741824, 0
  v_or_b32 v3, s58, v3
  s_mov_b32 s14, 0
L_G1:
  s_add_u32 s58, s56, 0
  buffer_load_dwordx4 v[64:67], v1, s[48:51], s58 offen sc1
  s_add_u32 s58, s56, 16384
  buffer_load_dwordx4 v[68:71], v1, s[48:51], s58 offen sc1
  s_add_u32 s58, s56, 32768
  buffer_load_dwordx4 v[72:75], v1, s[48:51], s58 offen sc1
  s_add_u32 s58, s56, 49152
  buffer_load_dwordx4 v[76:79], v1, s[48:51], s58 offen sc1
  s_add_u32 s14, s14, 1
  s_waitcnt vmcnt(0)
  v_xor_b32 v64, s16, v64
  v_xor_b32 v65, s17, v65
  v_xor_b32 v66, s18, v66
  v_xor_b32 v67, s19, v67
  v_xor_b32 v68, s16, v68
  v_xor_b32 v69, s17, v69
  v_xor_b32 v70, s18, v70
  v_xor_b32 v71, s19, v71
  v_xor_b32 v72, s16, v72
  v_xor_b32 v73, s17, v73
  v_xor_b32 v74, s18, v74
  v_xor_b32 v75, s19, v75
  v_xor_b32 v76, s16, v76
  v_xor_b32 v77, s17, v77
  v_xor_b32 v78, s18, v78
  v_xor_b32 v79, s19, v79
  v_or3_b32 v100, v64, v65, v66
  v_or3_b32 v100, v100, v67, v68
  v_or3_b32 v100, v100, v69, v70
  v_or3_b32 v100, v100, v71, v72
  v_or3_b32 v100, v100, v73, v74
  v_or3_b32 v100, v100, v75, v76
  v_or3_b32 v100, v100, v77, v78
  v_or_b32 v100, v100, v79
  v_and_b32 v100, 0xff, v100
  v_cmp_ne_u32 vcc, 0, v100
  s_cmp_ge_u32 s14, 200000
  s_cbranch_scc1 L_G1X
  s_cbranch_vccnz L_G1
L_G1X:
  v_add_f32 v64, v64, v68
  v_add_f32 v72, v72, v76
  v_add_f32 v65, v65, v69
  v_add_f32 v73, v73, v77
  v_add_f32 v66, v66, v70
  v_add_f32 v74, v74, v78
  v_add_f32 v67, v67, v71
  v_add_f32 v75, v75, v79
  v_add_f32 v64, v64, v72
  v_add_f32 v65, v65, v73
  v_add_f32 v66, v66, v74
  v_add_f32 v67, v67, v75
  v_cvt_pk_bf16_f32 v64, v64, v65
  v_cvt_pk_bf16_f32 v65, v66, v67
  v_lshlrev_b32 v2, 3, v0
  ds_write_b64 v2, v[64:65] offset:16384
  s_waitcnt lgkmcnt(0)
  s_barrier
  s_cmp_eq_u32 s34, 0
  s_cbranch_scc1 L_NOH
  s_mov_b32 s14, 0
L_G1B:
  s_add_u32 s58, s57, 0
  buffer_load_dwordx4 v[80:83], v3, s[48:51], s58 offen sc1
  s_add_u32 s58, s57, 18432
  buffer_load_dwordx4 v[84:87], v3, s[48:51], s58 offen sc1
  s_add_u32 s58, s57, 36864
  buffer_load_dwordx4 v[88:91], v3, s[48:51], s58 offen sc1
  s_add_u32 s14, s14, 1
  s_waitcnt vmcnt(0)
L_G1B_CHK:
  v_xor_b32 v80, s16, v80
  v_xor_b32 v81, s17, v81
  v_xor_b32 v82, s18, v82
  v_xor_b32 v83, s19, v83
  v_xor_b32 v84, s16, v84
  v_xor_b32 v85, s17, v85
  v_xor_b32 v86, s18, v86
  v_xor_b32 v87, s19, v87
  v_xor_b32 v88, s16, v88
  v_xor_b32 v89, s17, v89
  v_xor_b32 v90, s18, v90
  v_xor_b32 v91, s19, v91
  v_or3_b32 v104, v80, v81, v82
  v_or3_b32 v104, v104, v83, v84
  v_or3_b32 v104, v104, v85, v86
  v_or3_b32 v104, v104, v87, v88
  v_or3_b32 v104, v104, v89, v90
  v_or_b32 v104, v104, v91
  v_cmp_gt_u32 vcc, 1073741824, v3
  s_nop 1
  v_cndmask_b32 v104, 0, v104, vcc
  v_and_b32 v104, 0xff, v104
  v_cmp_ne_u32 vcc, 0, v104
  s_cmp_ge_u32 s14, 200000
  s_cbranch_scc1 L_G1BX
  s_cbranch_vccnz L_G1B
L_G1BX:
  v_add_f32 v80, v80, v84
  v_add_f32 v81, v81, v85
  v_add_f32 v82, v82, v86
  v_add_f32 v83, v83, v87
  v_add_f32 v80, v80, v88
  v_add_f32 v81, v81, v89
  v_add_f32 v82, v82, v90
  v_add_f32 v83, v83, v91
  v_cvt_pk_bf16_f32 v80, v80, v81
  v_cvt_pk_bf16_f32 v82, v82, v83
  v_and_b32 v81, 0xffff0000, v80
  v_lshlrev_b32 v80, 16, v80
  v_and_b32 v83, 0xffff0000, v82
  v_lshlrev_b32 v82, 16, v82
  v_lshlrev_b32 v84, 16, v20
  v_and_b32 v85, 0xffff0000, v20
  v_lshlrev_b32 v86, 16, v21
  v_and_b32 v87, 0xffff0000, v21
  v_add_f32 v80, v80, v84
  v_add_f32 v81, v81, v85
  v_add_f32 v82, v82, v86
  v_add_f32 v83, v83, v87
  v_cvt_pk_bf16_f32 v80, v80, v81
  v_cvt_pk_bf16_f32 v82, v82, v83
  v_and_b32 v81, 0xffff0000, v80
  v_lshlrev_b32 v80, 16, v80
  v_and_b32 v83, 0xffff0000, v82
  v_lshlrev_b32 v82, 16, v82
  s_mov_b32 s58, 0xc0135761
  v_mul_f32 v84, v80, v80
  v_mul_f32 v85, v81, v81
  v_mul_f32 v86, v82, v82
  v_mul_f32 v87, v83, v83
  v_mul_f32 v84, 0xbdd2d3e8, v84
  v_mul_f32 v85, 0xbdd2d3e8, v85
  v_mul_f32 v86, 0xbdd2d3e8, v86
  v_mul_f32 v87, 0xbdd2d3e8, v87
  v_add_f32 v84, s58, v84
  v_add_f32 v85, s58, v85
  v_add_f32 v86, s58, v86
  v_add_f32 v87, s58, v87
  v_mul_f32 v84, v84, v80
  v_mul_f32 v85, v85, v81
  v_mul_f32 v86, v86, v82
  v_mul_f32 v87, v87, v83
  v_exp_f32 v84, v84
  v_exp_f32 v85, v85
  v_exp_f32 v86, v86
  v_exp_f32 v87, v87
  v_add_f32 v84, 1.0, v84
  v_add_f32 v85, 1.0, v85
  v_add_f32 v86, 1.0, v86
  v_add_f32 v87, 1.0, v87
  v_rcp_f32 v84, v84
  v_rcp_f32 v85, v85
  v_rcp_f32 v86, v86
  v_rcp_f32 v87, v87
  v_mul_f32 v80, v80, v84
  v_mul_f32 v81, v81, v85
  v_mul_f32 v82, v82, v86
  v_mul_f32 v83, v83, v87
  v_cvt_pk_bf16_f32 v80, v80, v80
  v_cvt_pk_bf16_f32 v81, v81, v81
  v_cvt_pk_bf16_f32 v82, v82, v82
  v_cvt_pk_bf16_f32 v83, v83, v83
  v_and_b32 v84, 0xffff0000, v80
  v_and_b32 v80, 0xffff, v80
  v_and_b32 v85, 0xffff0000, v81
  v_and_b32 v81, 0xffff, v81
  v_and_b32 v86, 0xffff0000, v82
  v_and_b32 v82, 0xffff, v82
  v_and_b32 v87, 0xffff0000, v83
  v_and_b32 v83, 0xffff, v83
  v_lshlrev_b32 v2, 7, v0
  v_add_u32 v2, 10752, v2
  s_mov_b32 exec_lo, 0x3ffff
  s_mov_b32 exec_hi, 0
  ds_write2_b32 v2, v80, v84 offset0:3 offset1:7
  ds_write2_b32 v2, v81, v85 offset0:11 offset1:15
  ds_write2_b32 v2, v82, v86 offset0:19 offset1:23
  ds_write2_b32 v2, v83, v87 offset0:27 offset1:31
  s_mov_b64 exec, -1
L_NOH:
  v_lshrrev_b32 v2, 5, v0
  v_lshlrev_b32 v3, 3, v2
  v_add_u32 v3, 15360, v3
  s_lshr_b32 s56, s53, 1
  s_lshl_b32 s57, s55, 9
  s_lshl_b32 s58, s56, 4
  s_add_u32 s57, s57, s58
  s_add_u32 s57, s57, 126976
  v_lshlrev_b32 v22, 8, v2
  s_lshl_b32 s58, s55, 14
  s_lshl_b32 s61, s56, 8
  s_add_u32 s58, s58, s61
  s_add_u32 s15, s58, 135168
  v_lshlrev_b32 v23, 13, v2
  v_bfe_u32 v24, v0, 3, 1
  v_lshl_add_u32 v23, v24, 12, v23
  v_and_b32 v24, 7, v0
  v_lshl_add_u32 v23, v24, 5, v23
  v_bfe_u32 v24, v0, 4, 1
  v_lshl_add_u32 v23, v24, 4, v23
  s_mov_b32 s14, 0
L_ML:
  ds_read_b64 v[64:65], v3 offset:0
  ds_read_b64 v[66:67], v3 offset:16
  ds_read_b64 v[68:69], v3 offset:32
  ds_read_b64 v[70:71], v3 offset:48
  s_add_u32 s14, s14, 1
  s_waitcnt lgkmcnt(0)
  v_min_u32 v72, v65, v67
  v_min3_u32 v72, v72, v69, v71
  v_cmp_eq_u32 vcc, 0, v72
  s_cmp_ge_u32 s14, 2000000
  s_cbranch_scc1 L_MLX
  s_cbranch_vccnz L_ML
L_MLX:
  v_max3_f32 v72, v64, v66, v68
  v_max_f32 v72, v72, v70
  v_sub_f32 v64, v64, v72
  v_sub_f32 v66, v66, v72
  v_sub_f32 v68, v68, v72
  v_sub_f32 v70, v70, v72
  v_exp_f32 v48, v64
  v_exp_f32 v49, v66
  v_exp_f32 v50, v68
  v_exp_f32 v51, v70
  v_mul_f32 v73, v48, v65
  v_fmac_f32 v73, v49, v67
  v_fmac_f32 v73, v50, v69
  v_fmac_f32 v73, v51, v71
  v_mov_b32 v74, s32
  v_mov_b32 v75, s32
  s_mov_b32 exec_lo, 1
  s_mov_b32 exec_hi, 1
  buffer_store_dwordx4 v[72:75], v22, s[48:51], s57 offen sc1
  s_mov_b64 exec, -1
  s_lshl_b32 s58, s59, 12
  s_add_u32 s58, s58, 135168
  s_lshr_b32 s57, s59, 1
  s_lshl_b32 s57, s57, 8
  s_add_u32 s57, s57, 126976
  v_lshrrev_b32 v24, 4, v0
  v_add_u32 v24, v24, v0
  v_and_b32 v24, 15, v24
  v_lshlrev_b32 v24, 4, v24
  v_and_b32 v2, 15, v0
  v_lshlrev_b32 v2, 7, v2
  v_lshrrev_b32 v3, 4, v0
  v_lshl_add_u32 v2, v3, 5, v2
  v_add_u32 v2, 13056, v2
  s_mov_b32 s14, 0
  s_barrier
  ds_read_b128 v[64:67], v1 offset:17408
  ds_read_b128 v[68:71], v1 offset:18432
  ds_read_b128 v[72:75], v1 offset:19456
  ds_read_b128 v[76:79], v1 offset:20480
  s_waitcnt lgkmcnt(3)
  v_mul_f32 v80, v48, v64
  v_mul_f32 v81, v48, v65
  v_mul_f32 v82, v48, v66
  v_mul_f32 v83, v48, v67
  s_waitcnt lgkmcnt(2)
  v_fmac_f32 v80, v49, v68
  v_fmac_f32 v81, v49, v69
  v_fmac_f32 v82, v49, v70
  v_fmac_f32 v83, v49, v71
  s_waitcnt lgkmcnt(1)
  v_fmac_f32 v80, v50, v72
  v_fmac_f32 v81, v50, v73
  v_fmac_f32 v82, v50, v74
  v_fmac_f32 v83, v50, v75
  s_waitcnt lgkmcnt(0)
  v_fmac_f32 v80, v51, v76
  v_fmac_f32 v81, v51, v77
  v_fmac_f32 v82, v51, v78
  v_fmac_f32 v83, v51, v79
  v_perm_b32 v80, v80, v47, s8
  v_perm_b32 v81, v81, v47, s9
  v_perm_b32 v82, v82, v47, s10
  v_perm_b32 v83, v83, v47, s11
  buffer_store_dwordx4 v[80:83], v23, s[48:51], s15 offen sc1
  s_cmp_eq_u32 s34, 0
  s_cbranch_scc1 L_LIGHT
  s_waitcnt vmcnt(0)
  buffer_load_dwordx4 v[84:87], v24, s[48:51], s57 offen sc1
  buffer_load_dwordx4 v[64:67], v1, s[48:51], s58 offen offset:0 sc1
  buffer_load_dwordx4 v[68:71], v1, s[48:51], s58 offen offset:1024 sc1
  buffer_load_dwordx4 v[72:75], v1, s[48:51], s58 offen offset:2048 sc1
  buffer_load_dwordx4 v[76:79], v1, s[48:51], s58 offen offset:3072 sc1
  s_barrier
  s_branch L_G2W
L_G2:
  buffer_load_dwordx4 v[84:87], v24, s[48:51], s57 offen sc1
  buffer_load_dwordx4 v[64:67], v1, s[48:51], s58 offen offset:0 sc1
  buffer_load_dwordx4 v[68:71], v1, s[48:51], s58 offen offset:1024 sc1
  buffer_load_dwordx4 v[72:75], v1, s[48:51], s58 offen offset:2048 sc1
  buffer_load_dwordx4 v[76:79], v1, s[48:51], s58 offen offset:3072 sc1
L_G2W:
  s_add_u32 s14, s14, 1
  s_waitcnt vmcnt(4)
  v_xor_b32 v86, s32, v86
  v_xor_b32 v87, s32, v87
  v_or_b32 v101, v86, v87
  v_mov_b32 v88, v84
  s_nop 1
  v_max_f32_dpp v88, v88, v88 row_ror:8 row_mask:0xf bank_mask:0xf bound_ctrl:1
  s_nop 1
  v_max_f32_dpp v88, v88, v88 row_ror:4 row_mask:0xf bank_mask:0xf bound_ctrl:1
  s_nop 1
  v_max_f32_dpp v88, v88, v88 row_ror:2 row_mask:0xf bank_mask:0xf bound_ctrl:1
  s_nop 1
  v_max_f32_dpp v88, v88, v88 row_ror:1 row_mask:0xf bank_mask:0xf bound_ctrl:1
  v_sub_f32 v84, v84, v88
  v_exp_f32 v84, v84
  s_nop 0
  v_mul_f32 v85, v84, v85
  s_nop 1
  v_add_f32_dpp v85, v85, v85 row_ror:8 row_mask:0xf bank_mask:0xf bound_ctrl:1
  s_nop 1
  v_add_f32_dpp v85, v85, v85 row_ror:4 row_mask:0xf bank_mask:0xf bound_ctrl:1
  s_nop 1
  v_add_f32_dpp v85, v85, v85 row_ror:2 row_mask:0xf bank_mask:0xf bound_ctrl:1
  s_nop 1
  v_add_f32_dpp v85, v85, v85 row_ror:1 row_mask:0xf bank_mask:0xf bound_ctrl:1
  v_rcp_f32 v85, v85
  s_nop 0
  v_mul_f32 v52, v84, v85
  s_waitcnt vmcnt(0)
  v_xor_b32 v64, s16, v64
  v_xor_b32 v65, s17, v65
  v_xor_b32 v66, s18, v66
  v_xor_b32 v67, s19, v67
  v_xor_b32 v68, s16, v68
  v_xor_b32 v69, s17, v69
  v_xor_b32 v70, s18, v70
  v_xor_b32 v71, s19, v71
  v_xor_b32 v72, s16, v72
  v_xor_b32 v73, s17, v73
  v_xor_b32 v74, s18, v74
  v_xor_b32 v75, s19, v75
  v_xor_b32 v76, s16, v76
  v_xor_b32 v77, s17, v77
  v_xor_b32 v78, s18, v78
  v_xor_b32 v79, s19, v79
  v_or3_b32 v100, v64, v65, v66
  v_or3_b32 v100, v100, v67, v68
  v_or3_b32 v100, v100, v69, v70
  v_or3_b32 v100, v100, v71, v72
  v_or3_b32 v100, v100, v73, v74
  v_or3_b32 v100, v100, v75, v76
  v_or3_b32 v100, v100, v77, v78
  v_or_b32 v100, v100, v79
  v_and_b32 v100, 0xff, v100
  v_or_b32 v100, v100, v101
  v_cmp_ne_u32 vcc, 0, v100
  s_cmp_ge_u32 s14, 200000
  s_cbranch_scc1 L_G2X
  s_cbranch_vccnz L_G2
L_G2X:
  v_mul_f32_dpp v80, v52, v64 row_newbcast:0 row_mask:0xf bank_mask:0xf bound_ctrl:1
  v_mul_f32_dpp v81, v52, v65 row_newbcast:0 row_mask:0xf bank_mask:0xf bound_ctrl:1
  v_mul_f32_dpp v82, v52, v66 row_newbcast:0 row_mask:0xf bank_mask:0xf bound_ctrl:1
  v_mul_f32_dpp v83, v52, v67 row_newbcast:0 row_mask:0xf bank_mask:0xf bound_ctrl:1
  v_fmac_f32_dpp v80, v52, v68 row_newbcast:4 row_mask:0xf bank_mask:0xf bound_ctrl:1
  v_fmac_f32_dpp v81, v52, v69 row_newbcast:4 row_mask:0xf bank_mask:0xf bound_ctrl:1
  v_fmac_f32_dpp v82, v52, v70 row_newbcast:4 row_mask:0xf bank_mask:0xf bound_ctrl:1
  v_fmac_f32_dpp v83, v52, v71 row_newbcast:4 row_mask:0xf bank_mask:0xf bound_ctrl:1
  v_fmac_f32_dpp v80, v52, v72 row_newbcast:8 row_mask:0xf bank_mask:0xf bound_ctrl:1
  v_fmac_f32_dpp v81, v52, v73 row_newbcast:8 row_mask:0xf bank_mask:0xf bound_ctrl:1
  v_fmac_f32_dpp v82, v52, v74 row_newbcast:8 row_mask:0xf bank_mask:0xf bound_ctrl:1
  v_fmac_f32_dpp v83, v52, v75 row_newbcast:8 row_mask:0xf bank_mask:0xf bound_ctrl:1
  v_fmac_f32_dpp v80, v52, v76 row_newbcast:12 row_mask:0xf bank_mask:0xf bound_ctrl:1
  v_fmac_f32_dpp v81, v52, v77 row_newbcast:12 row_mask:0xf bank_mask:0xf bound_ctrl:1
  v_fmac_f32_dpp v82, v52, v78 row_newbcast:12 row_mask:0xf bank_mask:0xf bound_ctrl:1
  v_fmac_f32_dpp v83, v52, v79 row_newbcast:12 row_mask:0xf bank_mask:0xf bound_ctrl:1
  s_nop 0
  v_permlane32_swap_b32 v80, v82
  v_permlane32_swap_b32 v81, v83
  v_add_f32 v80, v80, v82
  v_add_f32 v81, v81, v83
  s_nop 1
  v_permlane16_swap_b32 v80, v81
  v_add_f32 v80, v80, v81
  v_cvt_pk_bf16_f32 v80, v80, v80
  v_and_b32 v81, 0xffff0000, v80
  v_and_b32 v80, 0xffff, v80
  ds_write2_b32 v2, v80, v81 offset0:3 offset1:7
  s_waitcnt lgkmcnt(0)
  s_barrier
  s_branch L_C_EXIT
L_LIGHT:
  s_cmp_lt_u32 s53, 27
  s_cbranch_scc1 L_C_EXIT
  s_sub_u32 s56, s53, 27
  s_lshl_b32 s56, s56, 3
  s_add_u32 s56, s56, s52
  s_cmp_ge_u32 s56, 36
  s_cbranch_scc1 L_C_EXIT
  v_and_b32 v2, 3, v0
  v_lshlrev_b32 v2, 2, v2
  v_lshrrev_b32 v3, 4, v0
  v_add_u32 v2, v2, v3
  v_lshlrev_b32 v2, 1, v2
  s_lshl_b32 s57, s56, 5
  buffer_load_ushort v22, v2, s[36:39], s57 offen
  s_lshl_b32 s58, s56, 12
  s_add_u32 s58, s58, 397312
  s_mov_b32 s14, 0
L_G3:
  buffer_load_dwordx4 v[64:67], v1, s[48:51], s58 offen offset:0 sc1
  buffer_load_dwordx4 v[68:71], v1, s[48:51], s58 offen offset:1024 sc1
  buffer_load_dwordx4 v[72:75], v1, s[48:51], s58 offen offset:2048 sc1
  buffer_load_dwordx4 v[76:79], v1, s[48:51], s58 offen offset:3072 sc1
  s_add_u32 s14, s14, 1
  s_waitcnt vmcnt(0)
  v_xor_b32 v64, s16, v64
  v_xor_b32 v65, s17, v65
  v_xor_b32 v66, s18, v66
  v_xor_b32 v67, s19, v67
  v_xor_b32 v68, s16, v68
  v_xor_b32 v69, s17, v69
  v_xor_b32 v70, s18, v70
  v_xor_b32 v71, s19, v71
  v_xor_b32 v72, s16, v72
  v_xor_b32 v73, s17, v73
  v_xor_b32 v74, s18, v74
  v_xor_b32 v75, s19, v75
  v_xor_b32 v76, s16, v76
  v_xor_b32 v77, s17, v77
  v_xor_b32 v78, s18, v78
  v_xor_b32 v79, s19, v79
  v_or3_b32 v100, v64, v65, v66
  v_or3_b32 v100, v100, v67, v68
  v_or3_b32 v100, v100, v69, v70
  v_or3_b32 v100, v100, v71, v72
  v_or3_b32 v100, v100, v73, v74
  v_or3_b32 v100, v100, v75, v76
  v_or3_b32 v100, v100, v77, v78
  v_or_b32 v100, v100, v79
  v_and_b32 v100, 0xff, v100
  v_cmp_ne_u32 vcc, 0, v100
  s_cmp_ge_u32 s14, 200000
  s_cbranch_scc1 L_G3X
  s_cbranch_vccnz L_G3
L_G3X:
  v_add_f32 v64, v64, v68
  v_add_f32 v72, v72, v76
  v_add_f32 v65, v65, v69
  v_add_f32 v73, v73, v77
  v_add_f32 v66, v66, v70
  v_add_f32 v74, v74, v78
  v_add_f32 v67, v67, v71
  v_add_f32 v75, v75, v79
  v_add_f32 v64, v64, v72
  v_add_f32 v65, v65, v73
  v_add_f32 v66, v66, v74
  v_add_f32 v67, v67, v75
  s_nop 0
  v_permlane32_swap_b32 v64, v66
  v_permlane32_swap_b32 v65, v67
  v_add_f32 v64, v64, v66
  v_add_f32 v65, v65, v67
  s_nop 1
  v_permlane16_swap_b32 v64, v65
  v_add_f32 v64, v64, v65
  v_lshlrev_b32 v22, 16, v22
  s_nop 0
  v_add_f32_dpp v64, v64, v64 row_ror:4 row_mask:0xf bank_mask:0xf bound_ctrl:1
  s_nop 1
  v_add_f32_dpp v64, v64, v64 row_ror:8 row_mask:0xf bank_mask:0xf bound_ctrl:1
  v_fmac_f32 v64, v45, v22
  v_cvt_pk_bf16_f32 v64, v64, v64
  s_mov_b32 exec_lo, 0x000f000f
  s_mov_b32 exec_hi, 0x000f000f
  buffer_store_short v64, v2, s[44:47], s57 offen
  s_cmp_lg_u32 s56, 0
  s_cbranch_scc1 L_C_EXIT
  s_add_u32 s33, s33, 1
  v_mov_b32 v2, 0
  v_mov_b32 v3, s33
  s_mov_b32 exec_lo, 1
  s_mov_b32 exec_hi, 0
  buffer_store_dword v3, v2, s[48:51], 0 offen
L_C_EXIT:
L_END:
  s_endpgm
.section .rodata,"a"
.p2align 6
.amdhsa_kernel gated_mix__sliding_block_cached__mixer_channel_mlp__decode_kernel
  .amdhsa_next_free_vgpr 200
  .amdhsa_next_free_sgpr 64
  .amdhsa_accum_offset 200
  .amdhsa_group_segment_fixed_size 0
  .amdhsa_kernarg_size 112
  .amdhsa_user_sgpr_count 2
  .amdhsa_user_sgpr_kernarg_segment_ptr 1
  .amdhsa_system_sgpr_workgroup_id_x 1
  .amdhsa_float_denorm_mode_32 3
.end_amdhsa_kernel
```
